```python
import torch

def _softmax(x, axis=-1):
    return torch.softmax(x, dim=axis)
def _gelu(x):
    return torch.nn.functional.gelu(x, approximate="tanh")
def _silu(x):
    return torch.nn.functional.silu(x)
def _sigmoid(x):
    return torch.sigmoid(x)
def _layernorm(x, axis=-1, eps=1e-5):
    m = x.mean(dim=axis, keepdim=True)
    v = x.var(dim=axis, keepdim=True, unbiased=False)
    return (x - m) / torch.sqrt(v + eps)
def _scatter_add(tgt, idx, src, axis=0):
    return tgt.clone().index_add_(axis, idx, src)
def _segment_sum(src, seg, n):
    out = torch.zeros((n,) + src.shape[1:], dtype=src.dtype)
    return out.index_add_(0, seg, src)
def _pad(x, pw):
    flat = tuple(v for pair in reversed(pw) for v in pair)
    return torch.nn.functional.pad(x, flat)

kernel_name = 'concat_heads__sliding_block_cached__mha_block_cached__decode'

def setup_inputs():

    _w = (lambda a: (lambda t: t.to(torch.bfloat16) if t.is_floating_point() else t)(torch.as_tensor(a)))
    def _A_setup():
        B, Sq, D = 2, 1, 512
        Hq, Hkv, Sk, Dh = 32, 8, 16384, 128
        assert Hq % Hkv == 0, (Hq, Hkv)
        return {
            "x": _w((lambda *s: torch.randn(*s, dtype=torch.bfloat16) * 0.8)(B, Sq, D)),
            "k_cache": _w((lambda *s: torch.randn(*s, dtype=torch.bfloat16) * 1.6)(B, Hkv, Sk, Dh)),
            "v_cache": _w((lambda *s: torch.randn(*s, dtype=torch.bfloat16) * 0.2)(B, Hkv, Sk, Dh)),
            "wq": _w((lambda *s: torch.randn(*s, dtype=torch.bfloat16) * 1.6)(D, Hq * Dh) * (D ** -0.5)),
            "wo": _w((lambda *s: torch.randn(*s, dtype=torch.bfloat16) * 0.2)(Hq * Dh, D) * ((Hq * Dh) ** -0.5)),
        }
    _A_in = _A_setup()

    def _B_setup():
        B, Sq, D = 2, 1, 512
        H, Sk, Dh = 32, 16384, 128
        return {
            "x": _w((lambda *s: torch.randn(*s, dtype=torch.bfloat16) * 0.8)(B, Sq, D)),
            "k_cache": _w((lambda *s: torch.randn(*s, dtype=torch.bfloat16) * 1.6)(B, H, Sk, Dh)),
            "v_cache": _w((lambda *s: torch.randn(*s, dtype=torch.bfloat16) * 0.2)(B, H, Sk, Dh)),
            "wq": _w((lambda *s: torch.randn(*s, dtype=torch.bfloat16) * 1.6)(D, H * Dh) * (D ** -0.5)),
            "wo": _w((lambda *s: torch.randn(*s, dtype=torch.bfloat16) * 0.2)(H * Dh, D) * ((H * Dh) ** -0.5)),
        }
    _B_in = _B_setup()

    return {
        "A_x": _A_in["x"],
        "A_k_cache": _A_in["k_cache"],
        "A_v_cache": _A_in["v_cache"],
        "A_wq": _A_in["wq"],
        "A_wo": _A_in["wo"],
        "B_x": _B_in["x"],
        "B_k_cache": _B_in["k_cache"],
        "B_v_cache": _B_in["v_cache"],
        "B_wq": _B_in["wq"],
        "B_wo": _B_in["wo"],
    }

def reference(A_x, A_k_cache, A_v_cache, A_wq, A_wo, B_x, B_k_cache, B_v_cache, B_wq, B_wo):
    def _A_ref(x, k_cache, v_cache, wq, wo):
        B, Sq, D = x.shape
        Hq, Dh = 32, 128
        Hkv, Sk = k_cache.shape[1], k_cache.shape[2]
        W = min(4096, max(256, Sk // 4))
        rep = Hq // Hkv
        q = (lambda x, *d: x.permute(*d))((x @ wq).reshape(B, Sq, Hq, Dh), 0, 2, 1, 3)
        k = (lambda x, n, axis: torch.repeat_interleave(x, n, dim=axis))(k_cache[:, :, Sk - W:, :], rep, axis=1)
        v = (lambda x, n, axis: torch.repeat_interleave(x, n, dim=axis))(v_cache[:, :, Sk - W:, :], rep, axis=1)
        scores = torch.einsum("bhqd,bhkd->bhqk", q, k) * (Dh ** -0.5)
        p = _softmax(scores, axis=-1)
        o = torch.einsum("bhqk,bhkd->bhqd", p, v)
        return (lambda x, *d: x.permute(*d))(o, 0, 2, 1, 3).reshape(B, Sq, Hq * Dh) @ wo

    def _B_ref(x, k_cache, v_cache, wq, wo):
        B, Sq, D = x.shape
        H, Dh = 32, 128
        q = (lambda x, *d: x.permute(*d))((x @ wq).reshape(B, Sq, H, Dh), 0, 2, 1, 3)
        scores = torch.einsum("bhqd,bhkd->bhqk", q, k_cache) * (Dh ** -0.5)
        p = _softmax(scores, axis=-1)
        o = torch.einsum("bhqk,bhkd->bhqd", p, v_cache)
        return (lambda x, *d: x.permute(*d))(o, 0, 2, 1, 3).reshape(B, Sq, H * Dh) @ wo

    a = _A_ref(A_x, A_k_cache, A_v_cache, A_wq, A_wo)
    b = _B_ref(B_x, B_k_cache, B_v_cache, B_wq, B_wo)
    return torch.concatenate([a, b], axis=-1)
```

```asm
; @launch grid=(256,1,1) block=(512,1,1) lds=101120
.amdgcn_target "amdgcn-amd-amdhsa--gfx950"
.text
.globl concat_heads__sliding_block_cached__mha_block_cached__decode_kernel
.p2align 8
.type concat_heads__sliding_block_cached__mha_block_cached__decode_kernel,@function
concat_heads__sliding_block_cached__mha_block_cached__decode_kernel:
    s_cmp_ge_u32 s2, 256
    s_cbranch_scc1 L_end
    s_load_dwordx16 s[16:31], s[0:1], 0
    s_load_dwordx8 s[32:39], s[0:1], 64
    s_load_dwordx2 s[40:41], s[0:1], 96
    v_and_b32 v1, 63, v0
    v_lshrrev_b32 v3, 6, v0
    v_lshlrev_b32 v2, 4, v1
    v_readfirstlane_b32 s3, v3
    s_lshr_b32 s72, s2, 3
    s_and_b32 s73, s2, 7
    s_mov_b32 s43, 0x3e0293ee
    s_mov_b32 s97, 0x05040100
    s_mov_b32 s98, 0x07060302
    s_waitcnt lgkmcnt(0)
    s_load_dword s42, s[40:41], 0
    s_mov_b32 s15, 0
    s_mov_b32 s44, s18
    s_and_b32 s45, s19, 0xffff
    s_mov_b32 s46, 0x4000000
    s_mov_b32 s47, 0x00020000
    s_mov_b32 s48, s20
    s_and_b32 s49, s21, 0xffff
    s_mov_b32 s50, 0x4000000
    s_mov_b32 s51, 0x00020000
    s_mov_b32 s52, s28
    s_and_b32 s53, s29, 0xffff
    s_mov_b32 s54, 0x10000000
    s_mov_b32 s55, 0x00020000
    s_mov_b32 s56, s30
    s_and_b32 s57, s31, 0xffff
    s_mov_b32 s58, 0x10000000
    s_mov_b32 s59, 0x00020000
    s_mov_b32 s60, s40
    s_and_b32 s61, s41, 0xffff
    s_mov_b32 s62, 0x500000
    s_mov_b32 s63, 0x00020000
    s_cmp_lg_u32 s3, 0
    s_cbranch_scc1 L_notsvc_1
    s_setprio 3
    s_lshr_b32 s6, s2, 7
    s_and_b32 s4, s2, 127
    s_and_b32 s5, s4, 7
    s_lshl_b32 s5, s5, 4
    s_lshr_b32 s4, s4, 3
    s_or_b32 s99, s5, s4
    s_cmp_eq_u32 s6, 0
    s_cselect_b32 s8, s22, s32
    s_cselect_b32 s9, s23, s33
    s_cselect_b32 s10, s16, s26
    s_cselect_b32 s11, s17, s27
    s_mov_b32 s64, s8
    s_and_b32 s65, s9, 0xffff
    s_mov_b32 s66, 0x400000
    s_mov_b32 s67, 0x00020000
    s_mov_b32 s68, s10
    s_and_b32 s69, s11, 0xffff
    s_mov_b32 s70, 0x800
    s_mov_b32 s71, 0x00020000
    v_lshrrev_b32 v3, 2, v1
    v_and_b32 v4, 3, v1
    v_lshlrev_b32 v5, 18, v3
    v_lshl_add_u32 v5, v4, 4, v5
    v_lshlrev_b32 v6, 6, v3
    s_lshl_b32 s7, s99, 6
    buffer_load_dwordx4 v[60:63], v6, s[68:71], 0 offen offset:0
    buffer_load_dwordx4 v[64:67], v6, s[68:71], 0 offen offset:16
    buffer_load_dwordx4 v[68:71], v6, s[68:71], 0 offen offset:32
    buffer_load_dwordx4 v[72:75], v6, s[68:71], 0 offen offset:48
    buffer_load_dwordx4 v[76:79], v6, s[68:71], 0 offen offset:1024
    buffer_load_dwordx4 v[80:83], v6, s[68:71], 0 offen offset:1040
    buffer_load_dwordx4 v[84:87], v6, s[68:71], 0 offen offset:1056
    buffer_load_dwordx4 v[88:91], v6, s[68:71], 0 offen offset:1072
    buffer_load_dwordx4 v[128:131], v5, s[64:67], s7 offen nt
    s_add_u32 s7, s7, 8192
    buffer_load_dwordx4 v[132:135], v5, s[64:67], s7 offen nt
    s_add_u32 s7, s7, 8192
    buffer_load_dwordx4 v[136:139], v5, s[64:67], s7 offen nt
    s_add_u32 s7, s7, 8192
    buffer_load_dwordx4 v[140:143], v5, s[64:67], s7 offen nt
    s_add_u32 s7, s7, 8192
    buffer_load_dwordx4 v[144:147], v5, s[64:67], s7 offen nt
    s_add_u32 s7, s7, 8192
    buffer_load_dwordx4 v[148:151], v5, s[64:67], s7 offen nt
    s_add_u32 s7, s7, 8192
    buffer_load_dwordx4 v[152:155], v5, s[64:67], s7 offen nt
    s_add_u32 s7, s7, 8192
    buffer_load_dwordx4 v[156:159], v5, s[64:67], s7 offen nt
    s_add_u32 s7, s7, 8192
    buffer_load_dwordx4 v[160:163], v5, s[64:67], s7 offen nt
    s_add_u32 s7, s7, 8192
    buffer_load_dwordx4 v[164:167], v5, s[64:67], s7 offen nt
    s_add_u32 s7, s7, 8192
    buffer_load_dwordx4 v[168:171], v5, s[64:67], s7 offen nt
    s_add_u32 s7, s7, 8192
    buffer_load_dwordx4 v[172:175], v5, s[64:67], s7 offen nt
    s_add_u32 s7, s7, 8192
    buffer_load_dwordx4 v[176:179], v5, s[64:67], s7 offen nt
    s_add_u32 s7, s7, 8192
    buffer_load_dwordx4 v[180:183], v5, s[64:67], s7 offen nt
    s_add_u32 s7, s7, 8192
    buffer_load_dwordx4 v[184:187], v5, s[64:67], s7 offen nt
    s_add_u32 s7, s7, 8192
    buffer_load_dwordx4 v[188:191], v5, s[64:67], s7 offen nt
    s_add_u32 s7, s7, 8192
    buffer_load_dwordx4 v[192:195], v5, s[64:67], s7 offen nt
    s_add_u32 s7, s7, 8192
    buffer_load_dwordx4 v[196:199], v5, s[64:67], s7 offen nt
    s_add_u32 s7, s7, 8192
    buffer_load_dwordx4 v[200:203], v5, s[64:67], s7 offen nt
    s_add_u32 s7, s7, 8192
    buffer_load_dwordx4 v[204:207], v5, s[64:67], s7 offen nt
    s_add_u32 s7, s7, 8192
    buffer_load_dwordx4 v[208:211], v5, s[64:67], s7 offen nt
    s_add_u32 s7, s7, 8192
    buffer_load_dwordx4 v[212:215], v5, s[64:67], s7 offen nt
    s_add_u32 s7, s7, 8192
    buffer_load_dwordx4 v[216:219], v5, s[64:67], s7 offen nt
    s_add_u32 s7, s7, 8192
    buffer_load_dwordx4 v[220:223], v5, s[64:67], s7 offen nt
    s_add_u32 s7, s7, 8192
    buffer_load_dwordx4 v[224:227], v5, s[64:67], s7 offen nt
    s_add_u32 s7, s7, 8192
    buffer_load_dwordx4 v[228:231], v5, s[64:67], s7 offen nt
    s_add_u32 s7, s7, 8192
    buffer_load_dwordx4 v[232:235], v5, s[64:67], s7 offen nt
    s_add_u32 s7, s7, 8192
    buffer_load_dwordx4 v[236:239], v5, s[64:67], s7 offen nt
    s_add_u32 s7, s7, 8192
    buffer_load_dwordx4 v[240:243], v5, s[64:67], s7 offen nt
    s_add_u32 s7, s7, 8192
    buffer_load_dwordx4 v[244:247], v5, s[64:67], s7 offen nt
    s_add_u32 s7, s7, 8192
    buffer_load_dwordx4 v[248:251], v5, s[64:67], s7 offen nt
    s_add_u32 s7, s7, 8192
    buffer_load_dwordx4 v[252:255], v5, s[64:67], s7 offen nt
L_notsvc_1:
    s_nop 2
    s_barrier
    s_cmp_eq_u32 s3, 0
    s_cbranch_scc1 L_svc2_2
    s_setprio 2
    s_lshr_b32 s4, s2, 4
    s_lshl_b32 s4, s4, 22
    s_and_b32 s5, s2, 15
    s_lshl_b32 s5, s5, 16
    s_add_u32 s4, s4, s5
    s_add_u32 s4, s4, 0x300000
    s_lshl_b32 s5, s3, 12
    s_add_u32 s4, s4, s5
    v_and_b32 v3, 15, v1
    v_lshlrev_b32 v3, 8, v3
    v_lshrrev_b32 v4, 4, v1
    v_lshl_add_u32 v3, v4, 4, v3
    s_lshl_b32 s6, s3, 13
    s_add_u32 s6, s6, 35584
    s_add_u32 s5, s4, 0
    buffer_load_dwordx4 v[192:195], v3, s[44:47], s5 offen offset:0 nt
    buffer_load_dwordx4 v[196:199], v3, s[44:47], s5 offen offset:64 nt
    buffer_load_dwordx4 v[200:203], v3, s[44:47], s5 offen offset:128 nt
    buffer_load_dwordx4 v[204:207], v3, s[44:47], s5 offen offset:192 nt
    s_add_u32 m0, s6, 0
    s_nop 0
    buffer_load_dwordx4 v2, s[48:51], s5 offen offset:0 nt lds
    buffer_load_dwordx4 v2, s[48:51], s5 offen offset:1024 nt lds
    buffer_load_dwordx4 v2, s[48:51], s5 offen offset:2048 nt lds
    buffer_load_dwordx4 v2, s[48:51], s5 offen offset:3072 nt lds
    s_add_u32 s5, s4, 32768
    buffer_load_dwordx4 v[208:211], v3, s[44:47], s5 offen offset:0 nt
    buffer_load_dwordx4 v[212:215], v3, s[44:47], s5 offen offset:64 nt
    buffer_load_dwordx4 v[216:219], v3, s[44:47], s5 offen offset:128 nt
    buffer_load_dwordx4 v[220:223], v3, s[44:47], s5 offen offset:192 nt
    s_add_u32 m0, s6, 4096
    s_nop 0
    buffer_load_dwordx4 v2, s[48:51], s5 offen offset:0 nt lds
    buffer_load_dwordx4 v2, s[48:51], s5 offen offset:1024 nt lds
    buffer_load_dwordx4 v2, s[48:51], s5 offen offset:2048 nt lds
    buffer_load_dwordx4 v2, s[48:51], s5 offen offset:3072 nt lds
    s_add_u32 s74, s73, 0
    s_and_b32 s4, s74, 7
    s_lshr_b32 s85, s4, 2
    s_lshl_b32 s5, s85, 5
    s_add_u32 s5, s5, s72
    s_lshl_b32 s5, s5, 22
    s_and_b32 s4, s4, 3
    s_lshl_b32 s4, s4, 20
    s_add_u32 s5, s5, s4
    s_lshr_b32 s4, s74, 3
    s_lshl_b32 s4, s4, 15
    s_add_u32 s5, s5, s4
    s_lshl_b32 s4, s3, 12
    s_add_u32 s82, s5, s4
    buffer_load_dwordx4 v[128:131], v2, s[52:55], s82 offen offset:0 nt
    buffer_load_dwordx4 v[132:135], v2, s[52:55], s82 offen offset:1024 nt
    buffer_load_dwordx4 v[136:139], v2, s[52:55], s82 offen offset:2048 nt
    buffer_load_dwordx4 v[140:143], v2, s[52:55], s82 offen offset:3072 nt
    buffer_load_dwordx4 v[144:147], v2, s[56:59], s82 offen offset:0 nt
    buffer_load_dwordx4 v[148:151], v2, s[56:59], s82 offen offset:1024 nt
    buffer_load_dwordx4 v[152:155], v2, s[56:59], s82 offen offset:2048 nt
    buffer_load_dwordx4 v[156:159], v2, s[56:59], s82 offen offset:3072 nt
    s_add_u32 s74, s73, 8
    s_and_b32 s4, s74, 7
    s_lshr_b32 s86, s4, 2
    s_lshl_b32 s5, s86, 5
    s_add_u32 s5, s5, s72
    s_lshl_b32 s5, s5, 22
    s_and_b32 s4, s4, 3
    s_lshl_b32 s4, s4, 20
    s_add_u32 s5, s5, s4
    s_lshr_b32 s4, s74, 3
    s_lshl_b32 s4, s4, 15
    s_add_u32 s5, s5, s4
    s_lshl_b32 s4, s3, 12
    s_add_u32 s82, s5, s4
    buffer_load_dwordx4 v[160:163], v2, s[52:55], s82 offen offset:0 nt
    buffer_load_dwordx4 v[164:167], v2, s[52:55], s82 offen offset:1024 nt
    buffer_load_dwordx4 v[168:171], v2, s[52:55], s82 offen offset:2048 nt
    buffer_load_dwordx4 v[172:175], v2, s[52:55], s82 offen offset:3072 nt
    buffer_load_dwordx4 v[176:179], v2, s[56:59], s82 offen offset:0 nt
    buffer_load_dwordx4 v[180:183], v2, s[56:59], s82 offen offset:1024 nt
    buffer_load_dwordx4 v[184:187], v2, s[56:59], s82 offen offset:2048 nt
    buffer_load_dwordx4 v[188:191], v2, s[56:59], s82 offen offset:3072 nt
    s_setprio 1
    s_waitcnt lgkmcnt(0)
    s_add_u32 s42, s42, 0x9e3779b1
    s_branch L_waitq_3
L_svc2_2:
    s_nop 2
    v_lshlrev_b32 v3, 2, v1
    v_mov_b32 v4, 0
    v_mov_b32 v7, -1
    ds_write_b32 v3, v4 offset:18368
    ds_write_b32 v3, v4 offset:18624
    ds_write_b32 v3, v4 offset:18880
    ds_write_b32 v3, v4 offset:19136
    ds_write_b32 v3, v7 offset:19392
    ds_write_b32 v3, v7 offset:19648
    ds_write_b32 v3, v7 offset:19904
    ds_write_b32 v3, v7 offset:20160
    ds_write_b32 v3, v7 offset:20416
    v_cmp_eq_u32 vcc, 0, v1
    v_mov_b32 v8, 16
    s_nop 0
    v_cndmask_b32 v8, 0, v8, vcc
    v_cmp_gt_u32 vcc, 16, v1
    s_nop 0
    s_and_saveexec_b64 s[94:95], vcc
    ds_write_b32 v3, v8 offset:17920
    s_mov_b64 exec, s[94:95]
    s_waitcnt vmcnt(30)
    v_perm_b32 v92, v132, v128, s97
    v_perm_b32 v93, v132, v128, s98
    v_perm_b32 v94, v133, v129, s97
    v_perm_b32 v95, v133, v129, s98
    v_perm_b32 v96, v134, v130, s97
    v_perm_b32 v97, v134, v130, s98
    v_perm_b32 v98, v135, v131, s97
    v_perm_b32 v99, v135, v131, s98
    v_dot2_f32_bf16 v100, v92, v60, 0
    v_dot2_f32_bf16 v101, v93, v60, 0
    v_dot2_f32_bf16 v102, v94, v60, 0
    v_dot2_f32_bf16 v103, v95, v60, 0
    v_dot2_f32_bf16 v104, v96, v60, 0
    v_dot2_f32_bf16 v105, v97, v60, 0
    v_dot2_f32_bf16 v106, v98, v60, 0
    v_dot2_f32_bf16 v107, v99, v60, 0
    v_dot2_f32_bf16 v108, v92, v76, 0
    v_dot2_f32_bf16 v109, v93, v76, 0
    v_dot2_f32_bf16 v110, v94, v76, 0
    v_dot2_f32_bf16 v111, v95, v76, 0
    v_dot2_f32_bf16 v112, v96, v76, 0
    v_dot2_f32_bf16 v113, v97, v76, 0
    v_dot2_f32_bf16 v114, v98, v76, 0
    v_dot2_f32_bf16 v115, v99, v76, 0
    s_waitcnt vmcnt(28)
    v_perm_b32 v92, v140, v136, s97
    v_perm_b32 v93, v140, v136, s98
    v_perm_b32 v94, v141, v137, s97
    v_perm_b32 v95, v141, v137, s98
    v_perm_b32 v96, v142, v138, s97
    v_perm_b32 v97, v142, v138, s98
    v_perm_b32 v98, v143, v139, s97
    v_perm_b32 v99, v143, v139, s98
    v_dot2_f32_bf16 v100, v92, v61, v100
    v_dot2_f32_bf16 v101, v93, v61, v101
    v_dot2_f32_bf16 v102, v94, v61, v102
    v_dot2_f32_bf16 v103, v95, v61, v103
    v_dot2_f32_bf16 v104, v96, v61, v104
    v_dot2_f32_bf16 v105, v97, v61, v105
    v_dot2_f32_bf16 v106, v98, v61, v106
    v_dot2_f32_bf16 v107, v99, v61, v107
    v_dot2_f32_bf16 v108, v92, v77, v108
    v_dot2_f32_bf16 v109, v93, v77, v109
    v_dot2_f32_bf16 v110, v94, v77, v110
    v_dot2_f32_bf16 v111, v95, v77, v111
    v_dot2_f32_bf16 v112, v96, v77, v112
    v_dot2_f32_bf16 v113, v97, v77, v113
    v_dot2_f32_bf16 v114, v98, v77, v114
    v_dot2_f32_bf16 v115, v99, v77, v115
    s_waitcnt vmcnt(26)
    v_perm_b32 v92, v148, v144, s97
    v_perm_b32 v93, v148, v144, s98
    v_perm_b32 v94, v149, v145, s97
    v_perm_b32 v95, v149, v145, s98
    v_perm_b32 v96, v150, v146, s97
    v_perm_b32 v97, v150, v146, s98
    v_perm_b32 v98, v151, v147, s97
    v_perm_b32 v99, v151, v147, s98
    v_dot2_f32_bf16 v100, v92, v62, v100
    v_dot2_f32_bf16 v101, v93, v62, v101
    v_dot2_f32_bf16 v102, v94, v62, v102
    v_dot2_f32_bf16 v103, v95, v62, v103
    v_dot2_f32_bf16 v104, v96, v62, v104
    v_dot2_f32_bf16 v105, v97, v62, v105
    v_dot2_f32_bf16 v106, v98, v62, v106
    v_dot2_f32_bf16 v107, v99, v62, v107
    v_dot2_f32_bf16 v108, v92, v78, v108
    v_dot2_f32_bf16 v109, v93, v78, v109
    v_dot2_f32_bf16 v110, v94, v78, v110
    v_dot2_f32_bf16 v111, v95, v78, v111
    v_dot2_f32_bf16 v112, v96, v78, v112
    v_dot2_f32_bf16 v113, v97, v78, v113
    v_dot2_f32_bf16 v114, v98, v78, v114
    v_dot2_f32_bf16 v115, v99, v78, v115
    s_waitcnt vmcnt(24)
    v_perm_b32 v92, v156, v152, s97
    v_perm_b32 v93, v156, v152, s98
    v_perm_b32 v94, v157, v153, s97
    v_perm_b32 v95, v157, v153, s98
    v_perm_b32 v96, v158, v154, s97
    v_perm_b32 v97, v158, v154, s98
    v_perm_b32 v98, v159, v155, s97
    v_perm_b32 v99, v159, v155, s98
    v_dot2_f32_bf16 v100, v92, v63, v100
    v_dot2_f32_bf16 v101, v93, v63, v101
    v_dot2_f32_bf16 v102, v94, v63, v102
    v_dot2_f32_bf16 v103, v95, v63, v103
    v_dot2_f32_bf16 v104, v96, v63, v104
    v_dot2_f32_bf16 v105, v97, v63, v105
    v_dot2_f32_bf16 v106, v98, v63, v106
    v_dot2_f32_bf16 v107, v99, v63, v107
    v_dot2_f32_bf16 v108, v92, v79, v108
    v_dot2_f32_bf16 v109, v93, v79, v109
    v_dot2_f32_bf16 v110, v94, v79, v110
    v_dot2_f32_bf16 v111, v95, v79, v111
    v_dot2_f32_bf16 v112, v96, v79, v112
    v_dot2_f32_bf16 v113, v97, v79, v113
    v_dot2_f32_bf16 v114, v98, v79, v114
    v_dot2_f32_bf16 v115, v99, v79, v115
    s_waitcnt vmcnt(22)
    v_perm_b32 v92, v164, v160, s97
    v_perm_b32 v93, v164, v160, s98
    v_perm_b32 v94, v165, v161, s97
    v_perm_b32 v95, v165, v161, s98
    v_perm_b32 v96, v166, v162, s97
    v_perm_b32 v97, v166, v162, s98
    v_perm_b32 v98, v167, v163, s97
    v_perm_b32 v99, v167, v163, s98
    v_dot2_f32_bf16 v100, v92, v64, v100
    v_dot2_f32_bf16 v101, v93, v64, v101
    v_dot2_f32_bf16 v102, v94, v64, v102
    v_dot2_f32_bf16 v103, v95, v64, v103
    v_dot2_f32_bf16 v104, v96, v64, v104
    v_dot2_f32_bf16 v105, v97, v64, v105
    v_dot2_f32_bf16 v106, v98, v64, v106
    v_dot2_f32_bf16 v107, v99, v64, v107
    v_dot2_f32_bf16 v108, v92, v80, v108
    v_dot2_f32_bf16 v109, v93, v80, v109
    v_dot2_f32_bf16 v110, v94, v80, v110
    v_dot2_f32_bf16 v111, v95, v80, v111
    v_dot2_f32_bf16 v112, v96, v80, v112
    v_dot2_f32_bf16 v113, v97, v80, v113
    v_dot2_f32_bf16 v114, v98, v80, v114
    v_dot2_f32_bf16 v115, v99, v80, v115
    s_waitcnt vmcnt(20)
    v_perm_b32 v92, v172, v168, s97
    v_perm_b32 v93, v172, v168, s98
    v_perm_b32 v94, v173, v169, s97
    v_perm_b32 v95, v173, v169, s98
    v_perm_b32 v96, v174, v170, s97
    v_perm_b32 v97, v174, v170, s98
    v_perm_b32 v98, v175, v171, s97
    v_perm_b32 v99, v175, v171, s98
    v_dot2_f32_bf16 v100, v92, v65, v100
    v_dot2_f32_bf16 v101, v93, v65, v101
    v_dot2_f32_bf16 v102, v94, v65, v102
    v_dot2_f32_bf16 v103, v95, v65, v103
    v_dot2_f32_bf16 v104, v96, v65, v104
    v_dot2_f32_bf16 v105, v97, v65, v105
    v_dot2_f32_bf16 v106, v98, v65, v106
    v_dot2_f32_bf16 v107, v99, v65, v107
    v_dot2_f32_bf16 v108, v92, v81, v108
    v_dot2_f32_bf16 v109, v93, v81, v109
    v_dot2_f32_bf16 v110, v94, v81, v110
    v_dot2_f32_bf16 v111, v95, v81, v111
    v_dot2_f32_bf16 v112, v96, v81, v112
    v_dot2_f32_bf16 v113, v97, v81, v113
    v_dot2_f32_bf16 v114, v98, v81, v114
    v_dot2_f32_bf16 v115, v99, v81, v115
    s_waitcnt vmcnt(18)
    v_perm_b32 v92, v180, v176, s97
    v_perm_b32 v93, v180, v176, s98
    v_perm_b32 v94, v181, v177, s97
    v_perm_b32 v95, v181, v177, s98
    v_perm_b32 v96, v182, v178, s97
    v_perm_b32 v97, v182, v178, s98
    v_perm_b32 v98, v183, v179, s97
    v_perm_b32 v99, v183, v179, s98
    v_dot2_f32_bf16 v100, v92, v66, v100
    v_dot2_f32_bf16 v101, v93, v66, v101
    v_dot2_f32_bf16 v102, v94, v66, v102
    v_dot2_f32_bf16 v103, v95, v66, v103
    v_dot2_f32_bf16 v104, v96, v66, v104
    v_dot2_f32_bf16 v105, v97, v66, v105
    v_dot2_f32_bf16 v106, v98, v66, v106
    v_dot2_f32_bf16 v107, v99, v66, v107
    v_dot2_f32_bf16 v108, v92, v82, v108
    v_dot2_f32_bf16 v109, v93, v82, v109
    v_dot2_f32_bf16 v110, v94, v82, v110
    v_dot2_f32_bf16 v111, v95, v82, v111
    v_dot2_f32_bf16 v112, v96, v82, v112
    v_dot2_f32_bf16 v113, v97, v82, v113
    v_dot2_f32_bf16 v114, v98, v82, v114
    v_dot2_f32_bf16 v115, v99, v82, v115
    s_waitcnt vmcnt(16)
    v_perm_b32 v92, v188, v184, s97
    v_perm_b32 v93, v188, v184, s98
    v_perm_b32 v94, v189, v185, s97
    v_perm_b32 v95, v189, v185, s98
    v_perm_b32 v96, v190, v186, s97
    v_perm_b32 v97, v190, v186, s98
    v_perm_b32 v98, v191, v187, s97
    v_perm_b32 v99, v191, v187, s98
    v_dot2_f32_bf16 v100, v92, v67, v100
    v_dot2_f32_bf16 v101, v93, v67, v101
    v_dot2_f32_bf16 v102, v94, v67, v102
    v_dot2_f32_bf16 v103, v95, v67, v103
    v_dot2_f32_bf16 v104, v96, v67, v104
    v_dot2_f32_bf16 v105, v97, v67, v105
    v_dot2_f32_bf16 v106, v98, v67, v106
    v_dot2_f32_bf16 v107, v99, v67, v107
    v_dot2_f32_bf16 v108, v92, v83, v108
    v_dot2_f32_bf16 v109, v93, v83, v109
    v_dot2_f32_bf16 v110, v94, v83, v110
    v_dot2_f32_bf16 v111, v95, v83, v111
    v_dot2_f32_bf16 v112, v96, v83, v112
    v_dot2_f32_bf16 v113, v97, v83, v113
    v_dot2_f32_bf16 v114, v98, v83, v114
    v_dot2_f32_bf16 v115, v99, v83, v115
    s_waitcnt vmcnt(14)
    v_perm_b32 v92, v196, v192, s97
    v_perm_b32 v93, v196, v192, s98
    v_perm_b32 v94, v197, v193, s97
    v_perm_b32 v95, v197, v193, s98
    v_perm_b32 v96, v198, v194, s97
    v_perm_b32 v97, v198, v194, s98
    v_perm_b32 v98, v199, v195, s97
    v_perm_b32 v99, v199, v195, s98
    v_dot2_f32_bf16 v100, v92, v68, v100
    v_dot2_f32_bf16 v101, v93, v68, v101
    v_dot2_f32_bf16 v102, v94, v68, v102
    v_dot2_f32_bf16 v103, v95, v68, v103
    v_dot2_f32_bf16 v104, v96, v68, v104
    v_dot2_f32_bf16 v105, v97, v68, v105
    v_dot2_f32_bf16 v106, v98, v68, v106
    v_dot2_f32_bf16 v107, v99, v68, v107
    v_dot2_f32_bf16 v108, v92, v84, v108
    v_dot2_f32_bf16 v109, v93, v84, v109
    v_dot2_f32_bf16 v110, v94, v84, v110
    v_dot2_f32_bf16 v111, v95, v84, v111
    v_dot2_f32_bf16 v112, v96, v84, v112
    v_dot2_f32_bf16 v113, v97, v84, v113
    v_dot2_f32_bf16 v114, v98, v84, v114
    v_dot2_f32_bf16 v115, v99, v84, v115
    s_waitcnt vmcnt(12)
    v_perm_b32 v92, v204, v200, s97
    v_perm_b32 v93, v204, v200, s98
    v_perm_b32 v94, v205, v201, s97
    v_perm_b32 v95, v205, v201, s98
    v_perm_b32 v96, v206, v202, s97
    v_perm_b32 v97, v206, v202, s98
    v_perm_b32 v98, v207, v203, s97
    v_perm_b32 v99, v207, v203, s98
    v_dot2_f32_bf16 v100, v92, v69, v100
    v_dot2_f32_bf16 v101, v93, v69, v101
    v_dot2_f32_bf16 v102, v94, v69, v102
    v_dot2_f32_bf16 v103, v95, v69, v103
    v_dot2_f32_bf16 v104, v96, v69, v104
    v_dot2_f32_bf16 v105, v97, v69, v105
    v_dot2_f32_bf16 v106, v98, v69, v106
    v_dot2_f32_bf16 v107, v99, v69, v107
    v_dot2_f32_bf16 v108, v92, v85, v108
    v_dot2_f32_bf16 v109, v93, v85, v109
    v_dot2_f32_bf16 v110, v94, v85, v110
    v_dot2_f32_bf16 v111, v95, v85, v111
    v_dot2_f32_bf16 v112, v96, v85, v112
    v_dot2_f32_bf16 v113, v97, v85, v113
    v_dot2_f32_bf16 v114, v98, v85, v114
    v_dot2_f32_bf16 v115, v99, v85, v115
    s_waitcnt vmcnt(10)
    v_perm_b32 v92, v212, v208, s97
    v_perm_b32 v93, v212, v208, s98
    v_perm_b32 v94, v213, v209, s97
    v_perm_b32 v95, v213, v209, s98
    v_perm_b32 v96, v214, v210, s97
    v_perm_b32 v97, v214, v210, s98
    v_perm_b32 v98, v215, v211, s97
    v_perm_b32 v99, v215, v211, s98
    v_dot2_f32_bf16 v100, v92, v70, v100
    v_dot2_f32_bf16 v101, v93, v70, v101
    v_dot2_f32_bf16 v102, v94, v70, v102
    v_dot2_f32_bf16 v103, v95, v70, v103
    v_dot2_f32_bf16 v104, v96, v70, v104
    v_dot2_f32_bf16 v105, v97, v70, v105
    v_dot2_f32_bf16 v106, v98, v70, v106
    v_dot2_f32_bf16 v107, v99, v70, v107
    v_dot2_f32_bf16 v108, v92, v86, v108
    v_dot2_f32_bf16 v109, v93, v86, v109
    v_dot2_f32_bf16 v110, v94, v86, v110
    v_dot2_f32_bf16 v111, v95, v86, v111
    v_dot2_f32_bf16 v112, v96, v86, v112
    v_dot2_f32_bf16 v113, v97, v86, v113
    v_dot2_f32_bf16 v114, v98, v86, v114
    v_dot2_f32_bf16 v115, v99, v86, v115
    s_waitcnt vmcnt(8)
    v_perm_b32 v92, v220, v216, s97
    v_perm_b32 v93, v220, v216, s98
    v_perm_b32 v94, v221, v217, s97
    v_perm_b32 v95, v221, v217, s98
    v_perm_b32 v96, v222, v218, s97
    v_perm_b32 v97, v222, v218, s98
    v_perm_b32 v98, v223, v219, s97
    v_perm_b32 v99, v223, v219, s98
    v_dot2_f32_bf16 v100, v92, v71, v100
    v_dot2_f32_bf16 v101, v93, v71, v101
    v_dot2_f32_bf16 v102, v94, v71, v102
    v_dot2_f32_bf16 v103, v95, v71, v103
    v_dot2_f32_bf16 v104, v96, v71, v104
    v_dot2_f32_bf16 v105, v97, v71, v105
    v_dot2_f32_bf16 v106, v98, v71, v106
    v_dot2_f32_bf16 v107, v99, v71, v107
    v_dot2_f32_bf16 v108, v92, v87, v108
    v_dot2_f32_bf16 v109, v93, v87, v109
    v_dot2_f32_bf16 v110, v94, v87, v110
    v_dot2_f32_bf16 v111, v95, v87, v111
    v_dot2_f32_bf16 v112, v96, v87, v112
    v_dot2_f32_bf16 v113, v97, v87, v113
    v_dot2_f32_bf16 v114, v98, v87, v114
    v_dot2_f32_bf16 v115, v99, v87, v115
    s_waitcnt vmcnt(6)
    v_perm_b32 v92, v228, v224, s97
    v_perm_b32 v93, v228, v224, s98
    v_perm_b32 v94, v229, v225, s97
    v_perm_b32 v95, v229, v225, s98
    v_perm_b32 v96, v230, v226, s97
    v_perm_b32 v97, v230, v226, s98
    v_perm_b32 v98, v231, v227, s97
    v_perm_b32 v99, v231, v227, s98
    v_dot2_f32_bf16 v100, v92, v72, v100
    v_dot2_f32_bf16 v101, v93, v72, v101
    v_dot2_f32_bf16 v102, v94, v72, v102
    v_dot2_f32_bf16 v103, v95, v72, v103
    v_dot2_f32_bf16 v104, v96, v72, v104
    v_dot2_f32_bf16 v105, v97, v72, v105
    v_dot2_f32_bf16 v106, v98, v72, v106
    v_dot2_f32_bf16 v107, v99, v72, v107
    v_dot2_f32_bf16 v108, v92, v88, v108
    v_dot2_f32_bf16 v109, v93, v88, v109
    v_dot2_f32_bf16 v110, v94, v88, v110
    v_dot2_f32_bf16 v111, v95, v88, v111
    v_dot2_f32_bf16 v112, v96, v88, v112
    v_dot2_f32_bf16 v113, v97, v88, v113
    v_dot2_f32_bf16 v114, v98, v88, v114
    v_dot2_f32_bf16 v115, v99, v88, v115
    s_waitcnt vmcnt(4)
    v_perm_b32 v92, v236, v232, s97
    v_perm_b32 v93, v236, v232, s98
    v_perm_b32 v94, v237, v233, s97
    v_perm_b32 v95, v237, v233, s98
    v_perm_b32 v96, v238, v234, s97
    v_perm_b32 v97, v238, v234, s98
    v_perm_b32 v98, v239, v235, s97
    v_perm_b32 v99, v239, v235, s98
    v_dot2_f32_bf16 v100, v92, v73, v100
    v_dot2_f32_bf16 v101, v93, v73, v101
    v_dot2_f32_bf16 v102, v94, v73, v102
    v_dot2_f32_bf16 v103, v95, v73, v103
    v_dot2_f32_bf16 v104, v96, v73, v104
    v_dot2_f32_bf16 v105, v97, v73, v105
    v_dot2_f32_bf16 v106, v98, v73, v106
    v_dot2_f32_bf16 v107, v99, v73, v107
    v_dot2_f32_bf16 v108, v92, v89, v108
    v_dot2_f32_bf16 v109, v93, v89, v109
    v_dot2_f32_bf16 v110, v94, v89, v110
    v_dot2_f32_bf16 v111, v95, v89, v111
    v_dot2_f32_bf16 v112, v96, v89, v112
    v_dot2_f32_bf16 v113, v97, v89, v113
    v_dot2_f32_bf16 v114, v98, v89, v114
    v_dot2_f32_bf16 v115, v99, v89, v115
    s_waitcnt vmcnt(2)
    v_perm_b32 v92, v244, v240, s97
    v_perm_b32 v93, v244, v240, s98
    v_perm_b32 v94, v245, v241, s97
    v_perm_b32 v95, v245, v241, s98
    v_perm_b32 v96, v246, v242, s97
    v_perm_b32 v97, v246, v242, s98
    v_perm_b32 v98, v247, v243, s97
    v_perm_b32 v99, v247, v243, s98
    v_dot2_f32_bf16 v100, v92, v74, v100
    v_dot2_f32_bf16 v101, v93, v74, v101
    v_dot2_f32_bf16 v102, v94, v74, v102
    v_dot2_f32_bf16 v103, v95, v74, v103
    v_dot2_f32_bf16 v104, v96, v74, v104
    v_dot2_f32_bf16 v105, v97, v74, v105
    v_dot2_f32_bf16 v106, v98, v74, v106
    v_dot2_f32_bf16 v107, v99, v74, v107
    v_dot2_f32_bf16 v108, v92, v90, v108
    v_dot2_f32_bf16 v109, v93, v90, v109
    v_dot2_f32_bf16 v110, v94, v90, v110
    v_dot2_f32_bf16 v111, v95, v90, v111
    v_dot2_f32_bf16 v112, v96, v90, v112
    v_dot2_f32_bf16 v113, v97, v90, v113
    v_dot2_f32_bf16 v114, v98, v90, v114
    v_dot2_f32_bf16 v115, v99, v90, v115
    s_waitcnt vmcnt(0)
    v_perm_b32 v92, v252, v248, s97
    v_perm_b32 v93, v252, v248, s98
    v_perm_b32 v94, v253, v249, s97
    v_perm_b32 v95, v253, v249, s98
    v_perm_b32 v96, v254, v250, s97
    v_perm_b32 v97, v254, v250, s98
    v_perm_b32 v98, v255, v251, s97
    v_perm_b32 v99, v255, v251, s98
    v_dot2_f32_bf16 v100, v92, v75, v100
    v_dot2_f32_bf16 v101, v93, v75, v101
    v_dot2_f32_bf16 v102, v94, v75, v102
    v_dot2_f32_bf16 v103, v95, v75, v103
    v_dot2_f32_bf16 v104, v96, v75, v104
    v_dot2_f32_bf16 v105, v97, v75, v105
    v_dot2_f32_bf16 v106, v98, v75, v106
    v_dot2_f32_bf16 v107, v99, v75, v107
    v_dot2_f32_bf16 v108, v92, v91, v108
    v_dot2_f32_bf16 v109, v93, v91, v109
    v_dot2_f32_bf16 v110, v94, v91, v110
    v_dot2_f32_bf16 v111, v95, v91, v111
    v_dot2_f32_bf16 v112, v96, v91, v112
    v_dot2_f32_bf16 v113, v97, v91, v113
    v_dot2_f32_bf16 v114, v98, v91, v114
    v_dot2_f32_bf16 v115, v99, v91, v115
    v_add_f32_dpp v100, v100, v100 row_ror:4 row_mask:0xf bank_mask:0xf
    v_add_f32_dpp v101, v101, v101 row_ror:4 row_mask:0xf bank_mask:0xf
    v_add_f32_dpp v102, v102, v102 row_ror:4 row_mask:0xf bank_mask:0xf
    v_add_f32_dpp v103, v103, v103 row_ror:4 row_mask:0xf bank_mask:0xf
    v_add_f32_dpp v104, v104, v104 row_ror:4 row_mask:0xf bank_mask:0xf
    v_add_f32_dpp v105, v105, v105 row_ror:4 row_mask:0xf bank_mask:0xf
    v_add_f32_dpp v106, v106, v106 row_ror:4 row_mask:0xf bank_mask:0xf
    v_add_f32_dpp v107, v107, v107 row_ror:4 row_mask:0xf bank_mask:0xf
    v_add_f32_dpp v108, v108, v108 row_ror:4 row_mask:0xf bank_mask:0xf
    v_add_f32_dpp v109, v109, v109 row_ror:4 row_mask:0xf bank_mask:0xf
    v_add_f32_dpp v110, v110, v110 row_ror:4 row_mask:0xf bank_mask:0xf
    v_add_f32_dpp v111, v111, v111 row_ror:4 row_mask:0xf bank_mask:0xf
    v_add_f32_dpp v112, v112, v112 row_ror:4 row_mask:0xf bank_mask:0xf
    v_add_f32_dpp v113, v113, v113 row_ror:4 row_mask:0xf bank_mask:0xf
    v_add_f32_dpp v114, v114, v114 row_ror:4 row_mask:0xf bank_mask:0xf
    v_add_f32_dpp v115, v115, v115 row_ror:4 row_mask:0xf bank_mask:0xf
    v_add_f32_dpp v100, v100, v100 row_ror:8 row_mask:0xf bank_mask:0xf
    v_add_f32_dpp v101, v101, v101 row_ror:8 row_mask:0xf bank_mask:0xf
    v_add_f32_dpp v102, v102, v102 row_ror:8 row_mask:0xf bank_mask:0xf
    v_add_f32_dpp v103, v103, v103 row_ror:8 row_mask:0xf bank_mask:0xf
    v_add_f32_dpp v104, v104, v104 row_ror:8 row_mask:0xf bank_mask:0xf
    v_add_f32_dpp v105, v105, v105 row_ror:8 row_mask:0xf bank_mask:0xf
    v_add_f32_dpp v106, v106, v106 row_ror:8 row_mask:0xf bank_mask:0xf
    v_add_f32_dpp v107, v107, v107 row_ror:8 row_mask:0xf bank_mask:0xf
    v_add_f32_dpp v108, v108, v108 row_ror:8 row_mask:0xf bank_mask:0xf
    v_add_f32_dpp v109, v109, v109 row_ror:8 row_mask:0xf bank_mask:0xf
    v_add_f32_dpp v110, v110, v110 row_ror:8 row_mask:0xf bank_mask:0xf
    v_add_f32_dpp v111, v111, v111 row_ror:8 row_mask:0xf bank_mask:0xf
    v_add_f32_dpp v112, v112, v112 row_ror:8 row_mask:0xf bank_mask:0xf
    v_add_f32_dpp v113, v113, v113 row_ror:8 row_mask:0xf bank_mask:0xf
    v_add_f32_dpp v114, v114, v114 row_ror:8 row_mask:0xf bank_mask:0xf
    v_add_f32_dpp v115, v115, v115 row_ror:8 row_mask:0xf bank_mask:0xf
    v_permlane16_swap_b32 v100, v104
    v_permlane16_swap_b32 v101, v105
    v_permlane16_swap_b32 v102, v106
    v_permlane16_swap_b32 v103, v107
    v_permlane16_swap_b32 v108, v112
    v_permlane16_swap_b32 v109, v113
    v_permlane16_swap_b32 v110, v114
    v_permlane16_swap_b32 v111, v115
    v_add_f32 v100, v100, v104
    v_add_f32 v101, v101, v105
    v_add_f32 v102, v102, v106
    v_add_f32 v103, v103, v107
    v_add_f32 v108, v108, v112
    v_add_f32 v109, v109, v113
    v_add_f32 v110, v110, v114
    v_add_f32 v111, v111, v115
    v_permlane32_swap_b32 v100, v108
    v_permlane32_swap_b32 v101, v109
    v_permlane32_swap_b32 v102, v110
    v_permlane32_swap_b32 v103, v111
    v_add_f32 v100, v100, v108
    v_add_f32 v101, v101, v109
    v_add_f32 v102, v102, v110
    v_add_f32 v103, v103, v111
    s_waitcnt lgkmcnt(0)
    s_add_u32 s42, s42, 0x9e3779b1
    v_cvt_pk_bf16_f32 v4, v100, v101
    v_cvt_pk_bf16_f32 v6, v102, v103
    v_mov_b32 v5, s42
    v_mov_b32 v7, s42
    s_lshr_b32 s6, s2, 7
    s_lshl_b32 s6, s6, 15
    s_lshl_b32 s5, s99, 7
    s_add_u32 s6, s6, s5
    s_add_u32 s6, s6, 0x10000
    v_lshrrev_b32 v8, 5, v1
    v_lshlrev_b32 v8, 14, v8
    v_and_b32 v9, 3, v1
    v_lshl_add_u32 v8, v9, 5, v8
    v_bfe_u32 v9, v1, 4, 1
    v_lshl_add_u32 v8, v9, 4, v8
    v_and_b32 v9, 12, v1
    v_cmp_eq_u32 vcc, 0, v9
    s_nop 0
    s_and_saveexec_b64 s[94:95], vcc
    buffer_store_dwordx4 v[4:7], v8, s[60:63], s6 offen sc0 sc1
    s_mov_b64 exec, s[94:95]
    s_cmp_lg_u32 s73, 0
    s_cbranch_scc1 L_cntinit_4
    s_lshl_b32 s4, s72, 10
    s_add_u32 s4, s4, 0x1000
    v_mov_b32 v3, s4
    v_mov_b32 v10, 0
    v_mov_b32 v11, s42
    s_mov_b64 s[94:95], exec
    s_mov_b64 exec, 1
    buffer_store_dwordx2 v[10:11], v3, s[60:63], 0 offen sc0 sc1
    s_mov_b64 exec, s[94:95]
L_cntinit_4:
    s_nop 2
    s_mov_b32 s96, 0
    v_lshrrev_b32 v8, 5, v1
    v_lshlrev_b32 v8, 14, v8
    v_and_b32 v9, 31, v1
    v_lshl_add_u32 v8, v9, 4, v8
    s_lshl_b32 s79, s72, 9
    s_add_u32 s79, s79, 0x18000
    s_lshr_b32 s80, s2, 7
    s_lshl_b32 s80, s80, 14
    s_lshr_b32 s6, s2, 4
    s_and_b32 s6, s6, 7
    s_lshl_b32 s6, s6, 11
    s_add_u32 s80, s80, s6
    s_add_u32 s80, s80, 0x10000
L_pollq_5:
    s_nop 2
    buffer_load_dwordx4 v[60:63], v8, s[60:63], s79 offen sc0 sc1
    buffer_load_dwordx4 v[64:67], v2, s[60:63], s80 offen sc0 sc1
    buffer_load_dwordx4 v[68:71], v2, s[60:63], s80 offen offset:1024 sc0 sc1
    s_waitcnt vmcnt(0)
    v_xor_b32 v24, s42, v61
    v_xor_b32 v25, s42, v63
    v_or_b32 v24, v24, v25
    v_xor_b32 v25, s42, v65
    v_or_b32 v24, v24, v25
    v_xor_b32 v25, s42, v67
    v_or_b32 v24, v24, v25
    v_xor_b32 v25, s42, v69
    v_or_b32 v24, v24, v25
    v_xor_b32 v25, s42, v71
    v_or_b32 v24, v24, v25
    v_cmp_ne_u32 vcc, 0, v24
    s_nop 0
    s_cmp_eq_u64 vcc, 0
    s_cbranch_scc1 L_pollq_ok_6
    s_add_u32 s96, s96, 1
    s_cmp_lt_u32 s96, 0x20000
    s_cbranch_scc1 L_pollq_5
L_pollq_ok_6:
    s_nop 2
    v_lshlrev_b32 v3, 3, v1
    v_mov_b32 v61, v62
    v_mov_b32 v65, v66
    v_mov_b32 v69, v70
    ds_write_b64 v3, v[60:61] offset:17408
    ds_write_b64 v3, v[64:65] offset:16384
    ds_write_b64 v3, v[68:69] offset:16896
    s_waitcnt lgkmcnt(0)
    v_mov_b32 v3, 17944
    v_mov_b32 v4, s42
    ds_write_b32 v3, v4
    s_not_b32 s4, s42
    v_mov_b32 v4, s4
    v_mov_b32 v5, s4
    v_mov_b32 v6, s4
    v_mov_b32 v7, s4
    s_lshl_b32 s5, s72, 4
    s_add_u32 s5, s5, s73
    s_lshl_b32 s6, s5, 10
    s_add_u32 s6, s6, 0x200000
    buffer_store_dwordx4 v[4:7], v2, s[60:63], s6 offen sc0 sc1
    s_add_u32 s6, s6, 8192
    buffer_store_dwordx4 v[4:7], v2, s[60:63], s6 offen sc0 sc1
    v_lshrrev_b32 v8, 5, v1
    v_lshlrev_b32 v8, 12, v8
    v_and_b32 v9, 31, v1
    v_lshl_add_u32 v8, v9, 4, v8
    s_lshl_b32 s6, s72, 13
    s_lshl_b32 s7, s73, 9
    s_add_u32 s6, s6, s7
    s_add_u32 s7, s6, 0x300000
    buffer_store_dwordx4 v[4:7], v8, s[60:63], s7 offen sc0 sc1
    s_add_u32 s7, s6, 0x340000
    buffer_store_dwordx4 v[4:7], v8, s[60:63], s7 offen sc0 sc1
    s_lshl_b32 s6, s5, 4
    s_add_u32 s6, s6, 0x28000
    v_lshlrev_b32 v8, 7, v1
    s_mov_b64 s[94:95], exec
    s_mov_b64 exec, 3
    buffer_store_dwordx4 v[4:7], v8, s[60:63], s6 offen sc0 sc1
    s_mov_b64 exec, 0xffff
    v_lshrrev_b32 v8, 3, v1
    v_lshlrev_b32 v8, 10, v8
    v_and_b32 v9, 7, v1
    v_lshl_add_u32 v8, v9, 4, v8
    s_lshl_b32 s6, s72, 11
    s_lshl_b32 s7, s73, 7
    s_add_u32 s6, s6, s7
    s_add_u32 s6, s6, 0x30000
    buffer_store_dwordx4 v[4:7], v8, s[60:63], s6 offen sc0 sc1
    s_mov_b64 exec, s[94:95]
    s_setprio 2
    s_lshr_b32 s4, s2, 4
    s_lshl_b32 s4, s4, 22
    s_and_b32 s5, s2, 15
    s_lshl_b32 s5, s5, 16
    s_add_u32 s4, s4, s5
    s_add_u32 s4, s4, 0x300000
    s_lshl_b32 s5, s3, 12
    s_add_u32 s4, s4, s5
    v_and_b32 v3, 15, v1
    v_lshlrev_b32 v3, 8, v3
    v_lshrrev_b32 v4, 4, v1
    v_lshl_add_u32 v3, v4, 4, v3
    s_lshl_b32 s6, s3, 13
    s_add_u32 s6, s6, 35584
    s_add_u32 s5, s4, 0
    buffer_load_dwordx4 v[192:195], v3, s[44:47], s5 offen offset:0 nt
    buffer_load_dwordx4 v[196:199], v3, s[44:47], s5 offen offset:64 nt
    buffer_load_dwordx4 v[200:203], v3, s[44:47], s5 offen offset:128 nt
    buffer_load_dwordx4 v[204:207], v3, s[44:47], s5 offen offset:192 nt
    s_add_u32 m0, s6, 0
    s_nop 0
    buffer_load_dwordx4 v2, s[48:51], s5 offen offset:0 nt lds
    buffer_load_dwordx4 v2, s[48:51], s5 offen offset:1024 nt lds
    buffer_load_dwordx4 v2, s[48:51], s5 offen offset:2048 nt lds
    buffer_load_dwordx4 v2, s[48:51], s5 offen offset:3072 nt lds
    s_add_u32 s5, s4, 32768
    buffer_load_dwordx4 v[208:211], v3, s[44:47], s5 offen offset:0 nt
    buffer_load_dwordx4 v[212:215], v3, s[44:47], s5 offen offset:64 nt
    buffer_load_dwordx4 v[216:219], v3, s[44:47], s5 offen offset:128 nt
    buffer_load_dwordx4 v[220:223], v3, s[44:47], s5 offen offset:192 nt
    s_add_u32 m0, s6, 4096
    s_nop 0
    buffer_load_dwordx4 v2, s[48:51], s5 offen offset:0 nt lds
    buffer_load_dwordx4 v2, s[48:51], s5 offen offset:1024 nt lds
    buffer_load_dwordx4 v2, s[48:51], s5 offen offset:2048 nt lds
    buffer_load_dwordx4 v2, s[48:51], s5 offen offset:3072 nt lds
    s_add_u32 s74, s73, 0
    s_and_b32 s4, s74, 7
    s_lshr_b32 s85, s4, 2
    s_lshl_b32 s5, s85, 5
    s_add_u32 s5, s5, s72
    s_lshl_b32 s5, s5, 22
    s_and_b32 s4, s4, 3
    s_lshl_b32 s4, s4, 20
    s_add_u32 s5, s5, s4
    s_lshr_b32 s4, s74, 3
    s_lshl_b32 s4, s4, 15
    s_add_u32 s5, s5, s4
    s_lshl_b32 s4, s3, 12
    s_add_u32 s82, s5, s4
    buffer_load_dwordx4 v[128:131], v2, s[52:55], s82 offen offset:0 nt
    buffer_load_dwordx4 v[132:135], v2, s[52:55], s82 offen offset:1024 nt
    buffer_load_dwordx4 v[136:139], v2, s[52:55], s82 offen offset:2048 nt
    buffer_load_dwordx4 v[140:143], v2, s[52:55], s82 offen offset:3072 nt
    buffer_load_dwordx4 v[144:147], v2, s[56:59], s82 offen offset:0 nt
    buffer_load_dwordx4 v[148:151], v2, s[56:59], s82 offen offset:1024 nt
    buffer_load_dwordx4 v[152:155], v2, s[56:59], s82 offen offset:2048 nt
    buffer_load_dwordx4 v[156:159], v2, s[56:59], s82 offen offset:3072 nt
    s_add_u32 s74, s73, 8
    s_and_b32 s4, s74, 7
    s_lshr_b32 s86, s4, 2
    s_lshl_b32 s5, s86, 5
    s_add_u32 s5, s5, s72
    s_lshl_b32 s5, s5, 22
    s_and_b32 s4, s4, 3
    s_lshl_b32 s4, s4, 20
    s_add_u32 s5, s5, s4
    s_lshr_b32 s4, s74, 3
    s_lshl_b32 s4, s4, 15
    s_add_u32 s5, s5, s4
    s_lshl_b32 s4, s3, 12
    s_add_u32 s82, s5, s4
    buffer_load_dwordx4 v[160:163], v2, s[52:55], s82 offen offset:0 nt
    buffer_load_dwordx4 v[164:167], v2, s[52:55], s82 offen offset:1024 nt
    buffer_load_dwordx4 v[168:171], v2, s[52:55], s82 offen offset:2048 nt
    buffer_load_dwordx4 v[172:175], v2, s[52:55], s82 offen offset:3072 nt
    buffer_load_dwordx4 v[176:179], v2, s[56:59], s82 offen offset:0 nt
    buffer_load_dwordx4 v[180:183], v2, s[56:59], s82 offen offset:1024 nt
    buffer_load_dwordx4 v[184:187], v2, s[56:59], s82 offen offset:2048 nt
    buffer_load_dwordx4 v[188:191], v2, s[56:59], s82 offen offset:3072 nt
    s_setprio 1
L_waitq_3:
    s_nop 2
    v_mov_b32 v3, 17944
    s_mov_b32 s96, 0
L_qspin_7:
    s_nop 2
    ds_read_b32 v4, v3
    s_waitcnt lgkmcnt(0)
    v_readfirstlane_b32 s4, v4
    s_nop 0
    s_cmp_eq_u32 s4, s42
    s_cbranch_scc1 L_qspin_ok_8
    s_sleep 1
    s_add_u32 s96, s96, 1
    s_cmp_lt_u32 s96, 0x400000
    s_cbranch_scc1 L_qspin_7
L_qspin_ok_8:
    s_nop 2
    v_bfe_u32 v3, v1, 2, 2
    v_lshlrev_b32 v3, 8, v3
    v_lshrrev_b32 v4, 4, v1
    v_lshl_add_u32 v3, v4, 4, v3
    ds_read_b128 v[60:63], v3 offset:16384
    ds_read_b128 v[64:67], v3 offset:16448
    ds_read_b128 v[68:71], v3 offset:16512
    ds_read_b128 v[72:75], v3 offset:16576
    s_waitcnt lgkmcnt(0)
    v_and_b32 v3, 15, v1
    v_lshlrev_b32 v3, 4, v3
    s_lshr_b32 s87, s73, 2
    s_lshl_b32 s4, s87, 8
    v_add_u32 v4, s4, v3
    s_xor_b32 s4, s4, 256
    v_add_u32 v5, s4, v3
    ds_read_b128 v[32:35], v4 offset:17408
    ds_read_b128 v[36:39], v5 offset:17408
    v_mov_b32 v40, 0
    v_mov_b32 v41, 0
    v_mov_b32 v42, 0
    v_mov_b32 v43, 0
    v_mov_b32 v44, 0
    v_mov_b32 v45, 0
    v_mov_b32 v46, 0
    v_mov_b32 v47, 0
    v_mov_b32 v56, 0xf149f2ca
    v_mov_b32 v57, 0
    v_mov_b32 v48, 0
    v_mov_b32 v49, 0
    v_mov_b32 v50, 0
    v_mov_b32 v51, 0
    v_mov_b32 v52, 0
    v_mov_b32 v53, 0
    v_mov_b32 v54, 0
    v_mov_b32 v55, 0
    v_mov_b32 v58, 0xf149f2ca
    v_mov_b32 v59, 0
    s_waitcnt lgkmcnt(0)
    s_lshl_b32 s4, s72, 10
    s_add_u32 s4, s4, 0x1000
    s_add_u32 s92, s40, s4
    s_addc_u32 s93, s41, 0
    s_mov_b32 s88, 0
    s_mov_b32 s89, 0
    s_mov_b32 s100, 0
    s_mov_b32 s99, 0
    s_setprio 1
    s_cmp_lt_u32 s3, 4
    s_cbranch_scc1 L_aprio_9
    s_setprio 2
L_aprio_9:
    s_nop 2
    v_mov_b32 v25, 17920
    v_mov_b32 v24, 1
    s_mov_b64 s[94:95], exec
    s_mov_b64 exec, 1
    ds_add_rtn_u32 v26, v25, v24
    s_mov_b64 exec, s[94:95]
    s_cmp_eq_u32 s85, s87
    s_cbranch_scc1 L_noswap_10
    v_swap_b32 v32, v36
    v_swap_b32 v33, v37
    v_swap_b32 v34, v38
    v_swap_b32 v35, v39
    v_swap_b32 v40, v48
    v_swap_b32 v41, v49
    v_swap_b32 v42, v50
    v_swap_b32 v43, v51
    v_swap_b32 v44, v52
    v_swap_b32 v45, v53
    v_swap_b32 v46, v54
    v_swap_b32 v47, v55
    v_swap_b32 v56, v58
    v_swap_b32 v57, v59
    s_mov_b32 s87, s85
    s_mov_b32 s99, 1
L_noswap_10:
    s_nop 2
    s_waitcnt vmcnt(12)
    v_dot2_f32_bf16 v3, v128, v32, 0
    v_dot2_f32_bf16 v4, v132, v32, 0
    v_dot2_f32_bf16 v5, v136, v32, 0
    v_dot2_f32_bf16 v6, v140, v32, 0
    v_dot2_f32_bf16 v3, v129, v33, v3
    v_dot2_f32_bf16 v4, v133, v33, v4
    v_dot2_f32_bf16 v5, v137, v33, v5
    v_dot2_f32_bf16 v6, v141, v33, v6
    v_dot2_f32_bf16 v3, v130, v34, v3
    v_dot2_f32_bf16 v4, v134, v34, v4
    v_dot2_f32_bf16 v5, v138, v34, v5
    v_dot2_f32_bf16 v6, v142, v34, v6
    v_dot2_f32_bf16 v3, v131, v35, v3
    v_dot2_f32_bf16 v4, v135, v35, v4
    v_dot2_f32_bf16 v5, v139, v35, v5
    v_dot2_f32_bf16 v6, v143, v35, v6
    s_waitcnt lgkmcnt(0)
    v_readfirstlane_b32 s74, v26
    s_nop 3
    s_mov_b32 s101, s74
    s_lshr_b32 s75, s74, 3
    s_and_b32 s76, s74, 7
    s_cmp_lt_u32 s74, 192
    s_cbranch_scc1 L_stat_12
    s_sub_u32 s74, s74, 192
    s_lshr_b32 s75, s74, 3
    s_and_b32 s76, s74, 7
    s_min_u32 s75, s75, 300
    s_cmp_lg_u32 s76, 0
    s_cbranch_scc1 L_norq_11
    s_add_u32 s89, s75, 1
    s_mov_b32 s90, 1
    s_mov_b32 s91, 0
    s_atomic_add_x2 s[90:91], s[92:93], 0 glc
    s_cmp_eq_u32 s89, 0
    s_cbranch_scc1 L_noreq_14
    s_waitcnt lgkmcnt(0)
    s_mov_b32 s96, 0
L_rqretry_15:
    s_nop 2
    s_cmp_eq_u32 s91, s42
    s_cbranch_scc1 L_rqok_16
    s_sleep 8
    s_mov_b32 s90, 1
    s_mov_b32 s91, 0
    s_atomic_add_x2 s[90:91], s[92:93], 0 glc
    s_waitcnt lgkmcnt(0)
    s_add_u32 s96, s96, 1
    s_cmp_lt_u32 s96, 0x20000
    s_cbranch_scc1 L_rqretry_15
L_rqok_16:
    s_nop 2
    s_sub_u32 s4, s89, 1
    s_lshl_b32 s4, s4, 2
    v_mov_b32 v24, s4
    v_mov_b32 v25, s90
    ds_write_b32 v24, v25 offset:19392
    s_mov_b32 s89, 0
L_noreq_14:
    s_nop 2
L_norq_11:
    s_nop 2
    s_lshl_b32 s4, s75, 2
    v_mov_b32 v24, s4
    s_mov_b32 s96, 0
L_dspin_17:
    s_nop 2
    ds_read_b32 v25, v24 offset:19392
    s_waitcnt lgkmcnt(0)
    v_readfirstlane_b32 s77, v25
    s_nop 3
    s_add_u32 s96, s96, 1
    s_cmp_ge_u32 s96, 0x400000
    s_cbranch_scc1 L_dgot_18
    s_cmp_eq_u32 s77, -1
    s_cbranch_scc1 L_dspin_17
L_dgot_18:
    s_nop 2
    s_min_u32 s77, s77, 4096
    s_add_u32 s77, s77, 192
    s_branch L_gotg_13
L_stat_12:
    s_nop 2
    s_lshl_b32 s77, s75, 3
    s_add_u32 s77, s77, s73
L_gotg_13:
    s_nop 2
    s_cmp_ge_u32 s77, 256
    s_cbranch_scc1 L_drain0
    s_and_b32 s4, s77, 7
    s_lshr_b32 s78, s4, 2
    s_lshl_b32 s5, s78, 5
    s_add_u32 s5, s5, s72
    s_lshl_b32 s5, s5, 22
    s_and_b32 s4, s4, 3
    s_lshl_b32 s4, s4, 20
    s_add_u32 s5, s5, s4
    s_lshr_b32 s4, s77, 3
    s_lshl_b32 s4, s4, 15
    s_add_u32 s5, s5, s4
    s_lshl_b32 s4, s76, 12
    s_add_u32 s83, s5, s4
    buffer_load_dwordx4 v[128:131], v2, s[52:55], s83 offen offset:0 nt
    buffer_load_dwordx4 v[132:135], v2, s[52:55], s83 offen offset:1024 nt
    buffer_load_dwordx4 v[136:139], v2, s[52:55], s83 offen offset:2048 nt
    buffer_load_dwordx4 v[140:143], v2, s[52:55], s83 offen offset:3072 nt
    v_add_f32_dpp v7, v3, v3 row_ror:8 row_mask:0xf bank_mask:0x3
    v_add_f32_dpp v7, v4, v4 row_ror:8 row_mask:0xf bank_mask:0xc
    v_add_f32_dpp v8, v5, v5 row_ror:8 row_mask:0xf bank_mask:0x3
    v_add_f32_dpp v8, v6, v6 row_ror:8 row_mask:0xf bank_mask:0xc
    v_add_f32_dpp v9, v7, v7 row_half_mirror row_mask:0xf bank_mask:0x5
    s_nop 0
    v_add_f32_dpp v9, v8, v8 row_half_mirror row_mask:0xf bank_mask:0xa
    s_nop 1
    v_add_f32_dpp v9, v9, v9 quad_perm:[1,0,3,2] row_mask:0xf bank_mask:0xf
    s_nop 1
    v_add_f32_dpp v9, v9, v9 quad_perm:[2,3,0,1] row_mask:0xf bank_mask:0xf
    s_nop 1
    v_max_f32_dpp v10, v9, v9 row_half_mirror row_mask:0xf bank_mask:0xf
    s_nop 1
    v_max_f32_dpp v10, v10, v10 row_ror:8 row_mask:0xf bank_mask:0xf
    v_max_f32 v10, v10, v56
    v_sub_f32 v12, v56, v10
    v_mul_f32 v13, s43, v10
    v_mul_f32 v12, s43, v12
    v_fma_f32 v13, v9, s43, -v13
    v_exp_f32 v11, v12
    v_exp_f32 v13, v13
    v_mov_b32 v56, v10
    v_cvt_pk_bf16_f32 v14, v13, 0
    v_lshlrev_b32 v15, 16, v14
    v_mul_f32 v40, v11, v40
    v_mul_f32 v41, v11, v41
    v_mul_f32 v42, v11, v42
    v_mul_f32 v43, v11, v43
    v_mul_f32 v44, v11, v44
    v_mul_f32 v45, v11, v45
    v_mul_f32 v46, v11, v46
    v_mul_f32 v47, v11, v47
    v_fma_f32 v57, v57, v11, v15
    s_waitcnt vmcnt(12)
    v_dot2c_f32_bf16_dpp v40, v14, v144 row_newbcast:0 row_mask:0xf bank_mask:0xf
    v_dot2c_f32_bf16_dpp v41, v15, v144 row_newbcast:0 row_mask:0xf bank_mask:0xf
    v_dot2c_f32_bf16_dpp v42, v14, v145 row_newbcast:0 row_mask:0xf bank_mask:0xf
    v_dot2c_f32_bf16_dpp v43, v15, v145 row_newbcast:0 row_mask:0xf bank_mask:0xf
    v_dot2c_f32_bf16_dpp v44, v14, v146 row_newbcast:0 row_mask:0xf bank_mask:0xf
    v_dot2c_f32_bf16_dpp v45, v15, v146 row_newbcast:0 row_mask:0xf bank_mask:0xf
    v_dot2c_f32_bf16_dpp v46, v14, v147 row_newbcast:0 row_mask:0xf bank_mask:0xf
    v_dot2c_f32_bf16_dpp v47, v15, v147 row_newbcast:0 row_mask:0xf bank_mask:0xf
    v_dot2c_f32_bf16_dpp v40, v14, v148 row_newbcast:8 row_mask:0xf bank_mask:0xf
    v_dot2c_f32_bf16_dpp v41, v15, v148 row_newbcast:8 row_mask:0xf bank_mask:0xf
    v_dot2c_f32_bf16_dpp v42, v14, v149 row_newbcast:8 row_mask:0xf bank_mask:0xf
    v_dot2c_f32_bf16_dpp v43, v15, v149 row_newbcast:8 row_mask:0xf bank_mask:0xf
    v_dot2c_f32_bf16_dpp v44, v14, v150 row_newbcast:8 row_mask:0xf bank_mask:0xf
    v_dot2c_f32_bf16_dpp v45, v15, v150 row_newbcast:8 row_mask:0xf bank_mask:0xf
    v_dot2c_f32_bf16_dpp v46, v14, v151 row_newbcast:8 row_mask:0xf bank_mask:0xf
    v_dot2c_f32_bf16_dpp v47, v15, v151 row_newbcast:8 row_mask:0xf bank_mask:0xf
    v_dot2c_f32_bf16_dpp v40, v14, v152 row_newbcast:4 row_mask:0xf bank_mask:0xf
    v_dot2c_f32_bf16_dpp v41, v15, v152 row_newbcast:4 row_mask:0xf bank_mask:0xf
    v_dot2c_f32_bf16_dpp v42, v14, v153 row_newbcast:4 row_mask:0xf bank_mask:0xf
    v_dot2c_f32_bf16_dpp v43, v15, v153 row_newbcast:4 row_mask:0xf bank_mask:0xf
    v_dot2c_f32_bf16_dpp v44, v14, v154 row_newbcast:4 row_mask:0xf bank_mask:0xf
    v_dot2c_f32_bf16_dpp v45, v15, v154 row_newbcast:4 row_mask:0xf bank_mask:0xf
    v_dot2c_f32_bf16_dpp v46, v14, v155 row_newbcast:4 row_mask:0xf bank_mask:0xf
    v_dot2c_f32_bf16_dpp v47, v15, v155 row_newbcast:4 row_mask:0xf bank_mask:0xf
    v_dot2c_f32_bf16_dpp v40, v14, v156 row_newbcast:12 row_mask:0xf bank_mask:0xf
    v_dot2c_f32_bf16_dpp v41, v15, v156 row_newbcast:12 row_mask:0xf bank_mask:0xf
    v_dot2c_f32_bf16_dpp v42, v14, v157 row_newbcast:12 row_mask:0xf bank_mask:0xf
    v_dot2c_f32_bf16_dpp v43, v15, v157 row_newbcast:12 row_mask:0xf bank_mask:0xf
    v_dot2c_f32_bf16_dpp v44, v14, v158 row_newbcast:12 row_mask:0xf bank_mask:0xf
    v_dot2c_f32_bf16_dpp v45, v15, v158 row_newbcast:12 row_mask:0xf bank_mask:0xf
    v_dot2c_f32_bf16_dpp v46, v14, v159 row_newbcast:12 row_mask:0xf bank_mask:0xf
    v_dot2c_f32_bf16_dpp v47, v15, v159 row_newbcast:12 row_mask:0xf bank_mask:0xf
    buffer_load_dwordx4 v[144:147], v2, s[56:59], s83 offen offset:0 nt
    buffer_load_dwordx4 v[148:151], v2, s[56:59], s83 offen offset:1024 nt
    buffer_load_dwordx4 v[152:155], v2, s[56:59], s83 offen offset:2048 nt
    buffer_load_dwordx4 v[156:159], v2, s[56:59], s83 offen offset:3072 nt
    s_mov_b32 s85, s78
    s_cmp_lg_u32 s3, 0
    s_cbranch_scc1 L_setclr_19
    v_mov_b32 v3, 17956
    v_mov_b32 v4, s42
    ds_write_b32 v3, v4
L_setclr_19:
    s_nop 2
    v_mov_b32 v25, 17920
    v_mov_b32 v24, 1
    s_mov_b64 s[94:95], exec
    s_mov_b64 exec, 1
    ds_add_rtn_u32 v26, v25, v24
    s_mov_b64 exec, s[94:95]
    s_cmp_eq_u32 s86, s87
    s_cbranch_scc1 L_noswap_20
    v_swap_b32 v32, v36
    v_swap_b32 v33, v37
    v_swap_b32 v34, v38
    v_swap_b32 v35, v39
    v_swap_b32 v40, v48
    v_swap_b32 v41, v49
    v_swap_b32 v42, v50
    v_swap_b32 v43, v51
    v_swap_b32 v44, v52
    v_swap_b32 v45, v53
    v_swap_b32 v46, v54
    v_swap_b32 v47, v55
    v_swap_b32 v56, v58
    v_swap_b32 v57, v59
    s_mov_b32 s87, s86
    s_mov_b32 s99, 1
L_noswap_20:
    s_nop 2
    s_waitcnt vmcnt(12)
    v_dot2_f32_bf16 v3, v160, v32, 0
    v_dot2_f32_bf16 v4, v164, v32, 0
    v_dot2_f32_bf16 v5, v168, v32, 0
    v_dot2_f32_bf16 v6, v172, v32, 0
    v_dot2_f32_bf16 v3, v161, v33, v3
    v_dot2_f32_bf16 v4, v165, v33, v4
    v_dot2_f32_bf16 v5, v169, v33, v5
    v_dot2_f32_bf16 v6, v173, v33, v6
    v_dot2_f32_bf16 v3, v162, v34, v3
    v_dot2_f32_bf16 v4, v166, v34, v4
    v_dot2_f32_bf16 v5, v170, v34, v5
    v_dot2_f32_bf16 v6, v174, v34, v6
    v_dot2_f32_bf16 v3, v163, v35, v3
    v_dot2_f32_bf16 v4, v167, v35, v4
    v_dot2_f32_bf16 v5, v171, v35, v5
    v_dot2_f32_bf16 v6, v175, v35, v6
    s_waitcnt lgkmcnt(0)
    v_readfirstlane_b32 s74, v26
    s_nop 3
    s_mov_b32 s101, s74
    s_lshr_b32 s75, s74, 3
    s_and_b32 s76, s74, 7
    s_cmp_lt_u32 s74, 192
    s_cbranch_scc1 L_stat_22
    s_sub_u32 s74, s74, 192
    s_lshr_b32 s75, s74, 3
    s_and_b32 s76, s74, 7
    s_min_u32 s75, s75, 300
    s_cmp_lg_u32 s76, 0
    s_cbranch_scc1 L_norq_21
    s_add_u32 s89, s75, 1
    s_mov_b32 s90, 1
    s_mov_b32 s91, 0
    s_atomic_add_x2 s[90:91], s[92:93], 0 glc
    s_cmp_eq_u32 s89, 0
    s_cbranch_scc1 L_noreq_24
    s_waitcnt lgkmcnt(0)
    s_mov_b32 s96, 0
L_rqretry_25:
    s_nop 2
    s_cmp_eq_u32 s91, s42
    s_cbranch_scc1 L_rqok_26
    s_sleep 8
    s_mov_b32 s90, 1
    s_mov_b32 s91, 0
    s_atomic_add_x2 s[90:91], s[92:93], 0 glc
    s_waitcnt lgkmcnt(0)
    s_add_u32 s96, s96, 1
    s_cmp_lt_u32 s96, 0x20000
    s_cbranch_scc1 L_rqretry_25
L_rqok_26:
    s_nop 2
    s_sub_u32 s4, s89, 1
    s_lshl_b32 s4, s4, 2
    v_mov_b32 v24, s4
    v_mov_b32 v25, s90
    ds_write_b32 v24, v25 offset:19392
    s_mov_b32 s89, 0
L_noreq_24:
    s_nop 2
L_norq_21:
    s_nop 2
    s_lshl_b32 s4, s75, 2
    v_mov_b32 v24, s4
    s_mov_b32 s96, 0
L_dspin_27:
    s_nop 2
    ds_read_b32 v25, v24 offset:19392
    s_waitcnt lgkmcnt(0)
    v_readfirstlane_b32 s77, v25
    s_nop 3
    s_add_u32 s96, s96, 1
    s_cmp_ge_u32 s96, 0x400000
    s_cbranch_scc1 L_dgot_28
    s_cmp_eq_u32 s77, -1
    s_cbranch_scc1 L_dspin_27
L_dgot_28:
    s_nop 2
    s_min_u32 s77, s77, 4096
    s_add_u32 s77, s77, 192
    s_branch L_gotg_23
L_stat_22:
    s_nop 2
    s_lshl_b32 s77, s75, 3
    s_add_u32 s77, s77, s73
L_gotg_23:
    s_nop 2
    s_cmp_ge_u32 s77, 256
    s_cbranch_scc1 L_drain1
    s_and_b32 s4, s77, 7
    s_lshr_b32 s78, s4, 2
    s_lshl_b32 s5, s78, 5
    s_add_u32 s5, s5, s72
    s_lshl_b32 s5, s5, 22
    s_and_b32 s4, s4, 3
    s_lshl_b32 s4, s4, 20
    s_add_u32 s5, s5, s4
    s_lshr_b32 s4, s77, 3
    s_lshl_b32 s4, s4, 15
    s_add_u32 s5, s5, s4
    s_lshl_b32 s4, s76, 12
    s_add_u32 s84, s5, s4
    buffer_load_dwordx4 v[160:163], v2, s[52:55], s84 offen offset:0 nt
    buffer_load_dwordx4 v[164:167], v2, s[52:55], s84 offen offset:1024 nt
    buffer_load_dwordx4 v[168:171], v2, s[52:55], s84 offen offset:2048 nt
    buffer_load_dwordx4 v[172:175], v2, s[52:55], s84 offen offset:3072 nt
    v_add_f32_dpp v7, v3, v3 row_ror:8 row_mask:0xf bank_mask:0x3
    v_add_f32_dpp v7, v4, v4 row_ror:8 row_mask:0xf bank_mask:0xc
    v_add_f32_dpp v8, v5, v5 row_ror:8 row_mask:0xf bank_mask:0x3
    v_add_f32_dpp v8, v6, v6 row_ror:8 row_mask:0xf bank_mask:0xc
    v_add_f32_dpp v9, v7, v7 row_half_mirror row_mask:0xf bank_mask:0x5
    s_nop 0
    v_add_f32_dpp v9, v8, v8 row_half_mirror row_mask:0xf bank_mask:0xa
    s_nop 1
    v_add_f32_dpp v9, v9, v9 quad_perm:[1,0,3,2] row_mask:0xf bank_mask:0xf
    s_nop 1
    v_add_f32_dpp v9, v9, v9 quad_perm:[2,3,0,1] row_mask:0xf bank_mask:0xf
    s_nop 1
    v_max_f32_dpp v10, v9, v9 row_half_mirror row_mask:0xf bank_mask:0xf
    s_nop 1
    v_max_f32_dpp v10, v10, v10 row_ror:8 row_mask:0xf bank_mask:0xf
    v_max_f32 v10, v10, v56
    v_sub_f32 v12, v56, v10
    v_mul_f32 v13, s43, v10
    v_mul_f32 v12, s43, v12
    v_fma_f32 v13, v9, s43, -v13
    v_exp_f32 v11, v12
    v_exp_f32 v13, v13
    v_mov_b32 v56, v10
    v_cvt_pk_bf16_f32 v14, v13, 0
    v_lshlrev_b32 v15, 16, v14
    v_mul_f32 v40, v11, v40
    v_mul_f32 v41, v11, v41
    v_mul_f32 v42, v11, v42
    v_mul_f32 v43, v11, v43
    v_mul_f32 v44, v11, v44
    v_mul_f32 v45, v11, v45
    v_mul_f32 v46, v11, v46
    v_mul_f32 v47, v11, v47
    v_fma_f32 v57, v57, v11, v15
    s_waitcnt vmcnt(12)
    v_dot2c_f32_bf16_dpp v40, v14, v176 row_newbcast:0 row_mask:0xf bank_mask:0xf
    v_dot2c_f32_bf16_dpp v41, v15, v176 row_newbcast:0 row_mask:0xf bank_mask:0xf
    v_dot2c_f32_bf16_dpp v42, v14, v177 row_newbcast:0 row_mask:0xf bank_mask:0xf
    v_dot2c_f32_bf16_dpp v43, v15, v177 row_newbcast:0 row_mask:0xf bank_mask:0xf
    v_dot2c_f32_bf16_dpp v44, v14, v178 row_newbcast:0 row_mask:0xf bank_mask:0xf
    v_dot2c_f32_bf16_dpp v45, v15, v178 row_newbcast:0 row_mask:0xf bank_mask:0xf
    v_dot2c_f32_bf16_dpp v46, v14, v179 row_newbcast:0 row_mask:0xf bank_mask:0xf
    v_dot2c_f32_bf16_dpp v47, v15, v179 row_newbcast:0 row_mask:0xf bank_mask:0xf
    v_dot2c_f32_bf16_dpp v40, v14, v180 row_newbcast:8 row_mask:0xf bank_mask:0xf
    v_dot2c_f32_bf16_dpp v41, v15, v180 row_newbcast:8 row_mask:0xf bank_mask:0xf
    v_dot2c_f32_bf16_dpp v42, v14, v181 row_newbcast:8 row_mask:0xf bank_mask:0xf
    v_dot2c_f32_bf16_dpp v43, v15, v181 row_newbcast:8 row_mask:0xf bank_mask:0xf
    v_dot2c_f32_bf16_dpp v44, v14, v182 row_newbcast:8 row_mask:0xf bank_mask:0xf
    v_dot2c_f32_bf16_dpp v45, v15, v182 row_newbcast:8 row_mask:0xf bank_mask:0xf
    v_dot2c_f32_bf16_dpp v46, v14, v183 row_newbcast:8 row_mask:0xf bank_mask:0xf
    v_dot2c_f32_bf16_dpp v47, v15, v183 row_newbcast:8 row_mask:0xf bank_mask:0xf
    v_dot2c_f32_bf16_dpp v40, v14, v184 row_newbcast:4 row_mask:0xf bank_mask:0xf
    v_dot2c_f32_bf16_dpp v41, v15, v184 row_newbcast:4 row_mask:0xf bank_mask:0xf
    v_dot2c_f32_bf16_dpp v42, v14, v185 row_newbcast:4 row_mask:0xf bank_mask:0xf
    v_dot2c_f32_bf16_dpp v43, v15, v185 row_newbcast:4 row_mask:0xf bank_mask:0xf
    v_dot2c_f32_bf16_dpp v44, v14, v186 row_newbcast:4 row_mask:0xf bank_mask:0xf
    v_dot2c_f32_bf16_dpp v45, v15, v186 row_newbcast:4 row_mask:0xf bank_mask:0xf
    v_dot2c_f32_bf16_dpp v46, v14, v187 row_newbcast:4 row_mask:0xf bank_mask:0xf
    v_dot2c_f32_bf16_dpp v47, v15, v187 row_newbcast:4 row_mask:0xf bank_mask:0xf
    v_dot2c_f32_bf16_dpp v40, v14, v188 row_newbcast:12 row_mask:0xf bank_mask:0xf
    v_dot2c_f32_bf16_dpp v41, v15, v188 row_newbcast:12 row_mask:0xf bank_mask:0xf
    v_dot2c_f32_bf16_dpp v42, v14, v189 row_newbcast:12 row_mask:0xf bank_mask:0xf
    v_dot2c_f32_bf16_dpp v43, v15, v189 row_newbcast:12 row_mask:0xf bank_mask:0xf
    v_dot2c_f32_bf16_dpp v44, v14, v190 row_newbcast:12 row_mask:0xf bank_mask:0xf
    v_dot2c_f32_bf16_dpp v45, v15, v190 row_newbcast:12 row_mask:0xf bank_mask:0xf
    v_dot2c_f32_bf16_dpp v46, v14, v191 row_newbcast:12 row_mask:0xf bank_mask:0xf
    v_dot2c_f32_bf16_dpp v47, v15, v191 row_newbcast:12 row_mask:0xf bank_mask:0xf
    buffer_load_dwordx4 v[176:179], v2, s[56:59], s84 offen offset:0 nt
    buffer_load_dwordx4 v[180:183], v2, s[56:59], s84 offen offset:1024 nt
    buffer_load_dwordx4 v[184:187], v2, s[56:59], s84 offen offset:2048 nt
    buffer_load_dwordx4 v[188:191], v2, s[56:59], s84 offen offset:3072 nt
    s_mov_b32 s86, s78
    v_lshrrev_b32 v3, 2, v1
    v_lshlrev_b32 v3, 8, v3
    v_and_b32 v4, 3, v1
    v_lshl_add_u32 v3, v4, 3, v3
    s_lshl_b32 s4, s3, 13
    v_add_u32 v3, s4, v3
    ds_read_b64_tr_b16 v[224:225], v3 offset:35584
    ds_read_b64_tr_b16 v[226:227], v3 offset:39680
    ds_read_b64_tr_b16 v[228:229], v3 offset:35616
    ds_read_b64_tr_b16 v[230:231], v3 offset:39712
    ds_read_b64_tr_b16 v[232:233], v3 offset:35648
    ds_read_b64_tr_b16 v[234:235], v3 offset:39744
    ds_read_b64_tr_b16 v[236:237], v3 offset:35680
    ds_read_b64_tr_b16 v[238:239], v3 offset:39776
    ds_read_b64_tr_b16 v[240:241], v3 offset:35712
    ds_read_b64_tr_b16 v[242:243], v3 offset:39808
    ds_read_b64_tr_b16 v[244:245], v3 offset:35744
    ds_read_b64_tr_b16 v[246:247], v3 offset:39840
    ds_read_b64_tr_b16 v[248:249], v3 offset:35776
    ds_read_b64_tr_b16 v[250:251], v3 offset:39872
    ds_read_b64_tr_b16 v[252:253], v3 offset:35808
    ds_read_b64_tr_b16 v[254:255], v3 offset:39904
    v_mfma_f32_16x16x32_bf16 v[108:111], v[192:195], v[60:63], 0
    v_mfma_f32_16x16x32_bf16 v[108:111], v[196:199], v[64:67], v[108:111]
    v_mfma_f32_16x16x32_bf16 v[108:111], v[200:203], v[68:71], v[108:111]
    v_mfma_f32_16x16x32_bf16 v[108:111], v[204:207], v[72:75], v[108:111]
    v_mfma_f32_16x16x32_bf16 v[112:115], v[208:211], v[60:63], 0
    v_mfma_f32_16x16x32_bf16 v[112:115], v[212:215], v[64:67], v[112:115]
    v_mfma_f32_16x16x32_bf16 v[112:115], v[216:219], v[68:71], v[112:115]
    v_mfma_f32_16x16x32_bf16 v[112:115], v[220:223], v[72:75], v[112:115]
    s_nop 7
    s_nop 1
    v_max3_f32 v5, v108, v109, v110
    v_max3_f32 v5, v5, v111, v112
    v_max3_f32 v5, v5, v113, v114
    v_max_f32 v5, v5, v115
    v_mov_b32 v6, v5
    s_nop 1
    v_permlane16_swap_b32 v5, v6
    v_max_f32 v5, v5, v6
    v_mov_b32 v6, v5
    s_nop 1
    v_permlane32_swap_b32 v5, v6
    v_max_f32 v5, v5, v6
    v_mul_f32 v6, s43, v5
    v_fma_f32 v108, v108, s43, -v6
    v_fma_f32 v109, v109, s43, -v6
    v_fma_f32 v110, v110, s43, -v6
    v_fma_f32 v111, v111, s43, -v6
    v_fma_f32 v112, v112, s43, -v6
    v_fma_f32 v113, v113, s43, -v6
    v_fma_f32 v114, v114, s43, -v6
    v_fma_f32 v115, v115, s43, -v6
    v_exp_f32 v108, v108
    v_exp_f32 v109, v109
    v_exp_f32 v110, v110
    v_exp_f32 v111, v111
    v_exp_f32 v112, v112
    v_exp_f32 v113, v113
    v_exp_f32 v114, v114
    v_exp_f32 v115, v115
    v_cvt_pk_bf16_f32 v16, v108, v109
    v_cvt_pk_bf16_f32 v17, v110, v111
    v_cvt_pk_bf16_f32 v18, v112, v113
    v_cvt_pk_bf16_f32 v19, v114, v115
    v_add_f32 v7, v108, v109
    v_add_f32 v8, v110, v111
    v_add_f32 v9, v112, v113
    v_add_f32 v10, v114, v115
    v_add_f32 v7, v7, v8
    v_add_f32 v9, v9, v10
    v_add_f32 v7, v7, v9
    v_mov_b32 v8, v7
    s_nop 1
    v_permlane16_swap_b32 v7, v8
    v_add_f32 v7, v7, v8
    v_mov_b32 v8, v7
    s_nop 1
    v_permlane32_swap_b32 v7, v8
    v_add_f32 v7, v7, v8
    s_waitcnt lgkmcnt(0)
    s_nop 1
    v_mfma_f32_16x16x32_bf16 v[76:79], v[16:19], v[224:227], 0
    v_mfma_f32_16x16x32_bf16 v[80:83], v[16:19], v[228:231], 0
    v_mfma_f32_16x16x32_bf16 v[84:87], v[16:19], v[232:235], 0
    v_mfma_f32_16x16x32_bf16 v[88:91], v[16:19], v[236:239], 0
    v_mfma_f32_16x16x32_bf16 v[92:95], v[16:19], v[240:243], 0
    v_mfma_f32_16x16x32_bf16 v[96:99], v[16:19], v[244:247], 0
    v_mfma_f32_16x16x32_bf16 v[100:103], v[16:19], v[248:251], 0
    v_mfma_f32_16x16x32_bf16 v[104:107], v[16:19], v[252:255], 0
    v_lshrrev_b32 v3, 2, v1
    v_lshlrev_b32 v3, 6, v3
    s_lshl_b32 s4, s3, 3
    v_add_u32 v3, s4, v3
    v_mov_b32 v8, v5
    v_mov_b32 v9, v7
    s_mov_b64 s[94:95], exec
    s_mov_b64 exec, 0x1111
    ds_write_b64 v3, v[8:9] offset:17984
    s_mov_b64 exec, s[94:95]
    v_lshrrev_b32 v3, 4, v1
    v_lshlrev_b32 v3, 9, v3
    v_and_b32 v4, 15, v1
    v_lshl_add_u32 v3, v4, 2, v3
    s_lshl_b32 s4, s3, 11
    v_add_u32 v3, s4, v3
    s_nop 7
    ds_write_b32 v3, v76 offset:0
    ds_write_b32 v3, v80 offset:64
    ds_write_b32 v3, v84 offset:128
    ds_write_b32 v3, v88 offset:192
    ds_write_b32 v3, v92 offset:256
    ds_write_b32 v3, v96 offset:320
    ds_write_b32 v3, v100 offset:384
    ds_write_b32 v3, v104 offset:448
    s_waitcnt lgkmcnt(0)
    v_mov_b32 v12, 17924
    v_mov_b32 v13, 1
    s_mov_b64 s[94:95], exec
    s_mov_b64 exec, 1
    ds_add_rtn_u32 v12, v12, v13
    s_mov_b64 exec, s[94:95]
    s_waitcnt lgkmcnt(0)
    v_readfirstlane_b32 s4, v12
    s_nop 3
    s_cmp_lg_u32 s4, 7
    s_cbranch_scc1 L_amerged_29
    s_lshr_b32 s74, s2, 7
    s_lshl_b32 s74, s74, 5
    s_lshr_b32 s75, s2, 4
    s_and_b32 s75, s75, 7
    s_lshl_b32 s75, s75, 2
    s_add_u32 s74, s74, s75
    s_lshl_b32 s74, s74, 4
    s_and_b32 s75, s2, 15
    s_add_u32 s74, s74, s75
    s_lshl_b32 s75, s74, 4
    s_add_u32 s75, s75, 0x20000
    s_lshl_b32 s74, s74, 10
    s_add_u32 s74, s74, 0x100000
    s_setprio 2
    v_lshlrev_b32 v3, 3, v1
    v_mov_b32 v4, 0
    ds_read_b64 v[16:17], v3 offset:0
    ds_read_b64 v[18:19], v3 offset:2048
    ds_read_b64 v[20:21], v3 offset:4096
    ds_read_b64 v[22:23], v3 offset:6144
    ds_read_b64 v[24:25], v3 offset:8192
    ds_read_b64 v[26:27], v3 offset:10240
    ds_read_b64 v[28:29], v3 offset:12288
    ds_read_b64 v[30:31], v3 offset:14336
    ds_read_b128 v[192:195], v4 offset:17984
    ds_read_b128 v[196:199], v4 offset:18000
    ds_read_b128 v[200:203], v4 offset:18016
    ds_read_b128 v[204:207], v4 offset:18032
    s_waitcnt lgkmcnt(0)
    v_max3_f32 v5, v192, v194, v196
    v_max3_f32 v5, v5, v198, v200
    v_max3_f32 v5, v5, v202, v204
    v_max_f32 v5, v5, v206
    v_sub_f32 v192, v192, v5
    v_mul_f32 v192, s43, v192
    v_exp_f32 v192, v192
    v_sub_f32 v194, v194, v5
    v_mul_f32 v194, s43, v194
    v_exp_f32 v194, v194
    v_sub_f32 v196, v196, v5
    v_mul_f32 v196, s43, v196
    v_exp_f32 v196, v196
    v_sub_f32 v198, v198, v5
    v_mul_f32 v198, s43, v198
    v_exp_f32 v198, v198
    v_sub_f32 v200, v200, v5
    v_mul_f32 v200, s43, v200
    v_exp_f32 v200, v200
    v_sub_f32 v202, v202, v5
    v_mul_f32 v202, s43, v202
    v_exp_f32 v202, v202
    v_sub_f32 v204, v204, v5
    v_mul_f32 v204, s43, v204
    v_exp_f32 v204, v204
    v_sub_f32 v206, v206, v5
    v_mul_f32 v206, s43, v206
    v_exp_f32 v206, v206
    s_nop 0
    v_mul_f32 v6, v192, v16
    v_mul_f32 v8, v192, v17
    v_mul_f32 v12, v192, v193
    v_fmac_f32 v6, v194, v18
    v_fmac_f32 v8, v194, v19
    v_fmac_f32 v12, v194, v195
    v_fmac_f32 v6, v196, v20
    v_fmac_f32 v8, v196, v21
    v_fmac_f32 v12, v196, v197
    v_fmac_f32 v6, v198, v22
    v_fmac_f32 v8, v198, v23
    v_fmac_f32 v12, v198, v199
    v_fmac_f32 v6, v200, v24
    v_fmac_f32 v8, v200, v25
    v_fmac_f32 v12, v200, v201
    v_fmac_f32 v6, v202, v26
    v_fmac_f32 v8, v202, v27
    v_fmac_f32 v12, v202, v203
    v_fmac_f32 v6, v204, v28
    v_fmac_f32 v8, v204, v29
    v_fmac_f32 v12, v204, v205
    v_fmac_f32 v6, v206, v30
    v_fmac_f32 v8, v206, v31
    v_fmac_f32 v12, v206, v207
    v_mov_b32 v7, s42
    v_mov_b32 v9, s42
    buffer_store_dwordx4 v[6:9], v2, s[60:63], s74 offen sc0 sc1
    v_mov_b32 v10, v5
    v_mov_b32 v11, s42
    v_mov_b32 v13, s42
    v_mov_b32 v4, 0
    s_mov_b64 s[94:95], exec
    s_mov_b64 exec, 1
    buffer_store_dwordx4 v[10:13], v4, s[60:63], s75 offen sc0 sc1
    s_mov_b64 exec, s[94:95]
    s_nop 1
    s_add_u32 s74, s74, 16384
    s_add_u32 s75, s75, 256
    v_lshlrev_b32 v3, 3, v1
    v_mov_b32 v4, 0
    ds_read_b64 v[16:17], v3 offset:512
    ds_read_b64 v[18:19], v3 offset:2560
    ds_read_b64 v[20:21], v3 offset:4608
    ds_read_b64 v[22:23], v3 offset:6656
    ds_read_b64 v[24:25], v3 offset:8704
    ds_read_b64 v[26:27], v3 offset:10752
    ds_read_b64 v[28:29], v3 offset:12800
    ds_read_b64 v[30:31], v3 offset:14848
    ds_read_b128 v[192:195], v4 offset:18048
    ds_read_b128 v[196:199], v4 offset:18064
    ds_read_b128 v[200:203], v4 offset:18080
    ds_read_b128 v[204:207], v4 offset:18096
    s_waitcnt lgkmcnt(0)
    v_max3_f32 v5, v192, v194, v196
    v_max3_f32 v5, v5, v198, v200
    v_max3_f32 v5, v5, v202, v204
    v_max_f32 v5, v5, v206
    v_sub_f32 v192, v192, v5
    v_mul_f32 v192, s43, v192
    v_exp_f32 v192, v192
    v_sub_f32 v194, v194, v5
    v_mul_f32 v194, s43, v194
    v_exp_f32 v194, v194
    v_sub_f32 v196, v196, v5
    v_mul_f32 v196, s43, v196
    v_exp_f32 v196, v196
    v_sub_f32 v198, v198, v5
    v_mul_f32 v198, s43, v198
    v_exp_f32 v198, v198
    v_sub_f32 v200, v200, v5
    v_mul_f32 v200, s43, v200
    v_exp_f32 v200, v200
    v_sub_f32 v202, v202, v5
    v_mul_f32 v202, s43, v202
    v_exp_f32 v202, v202
    v_sub_f32 v204, v204, v5
    v_mul_f32 v204, s43, v204
    v_exp_f32 v204, v204
    v_sub_f32 v206, v206, v5
    v_mul_f32 v206, s43, v206
    v_exp_f32 v206, v206
    s_nop 0
    v_mul_f32 v6, v192, v16
    v_mul_f32 v8, v192, v17
    v_mul_f32 v12, v192, v193
    v_fmac_f32 v6, v194, v18
    v_fmac_f32 v8, v194, v19
    v_fmac_f32 v12, v194, v195
    v_fmac_f32 v6, v196, v20
    v_fmac_f32 v8, v196, v21
    v_fmac_f32 v12, v196, v197
    v_fmac_f32 v6, v198, v22
    v_fmac_f32 v8, v198, v23
    v_fmac_f32 v12, v198, v199
    v_fmac_f32 v6, v200, v24
    v_fmac_f32 v8, v200, v25
    v_fmac_f32 v12, v200, v201
    v_fmac_f32 v6, v202, v26
    v_fmac_f32 v8, v202, v27
    v_fmac_f32 v12, v202, v203
    v_fmac_f32 v6, v204, v28
    v_fmac_f32 v8, v204, v29
    v_fmac_f32 v12, v204, v205
    v_fmac_f32 v6, v206, v30
    v_fmac_f32 v8, v206, v31
    v_fmac_f32 v12, v206, v207
    v_mov_b32 v7, s42
    v_mov_b32 v9, s42
    buffer_store_dwordx4 v[6:9], v2, s[60:63], s74 offen sc0 sc1
    v_mov_b32 v10, v5
    v_mov_b32 v11, s42
    v_mov_b32 v13, s42
    v_mov_b32 v4, 0
    s_mov_b64 s[94:95], exec
    s_mov_b64 exec, 1
    buffer_store_dwordx4 v[10:13], v4, s[60:63], s75 offen sc0 sc1
    s_mov_b64 exec, s[94:95]
    s_nop 1
    s_add_u32 s74, s74, 16384
    s_add_u32 s75, s75, 256
    v_lshlrev_b32 v3, 3, v1
    v_mov_b32 v4, 0
    ds_read_b64 v[16:17], v3 offset:1024
    ds_read_b64 v[18:19], v3 offset:3072
    ds_read_b64 v[20:21], v3 offset:5120
    ds_read_b64 v[22:23], v3 offset:7168
    ds_read_b64 v[24:25], v3 offset:9216
    ds_read_b64 v[26:27], v3 offset:11264
    ds_read_b64 v[28:29], v3 offset:13312
    ds_read_b64 v[30:31], v3 offset:15360
    ds_read_b128 v[192:195], v4 offset:18112
    ds_read_b128 v[196:199], v4 offset:18128
    ds_read_b128 v[200:203], v4 offset:18144
    ds_read_b128 v[204:207], v4 offset:18160
    s_waitcnt lgkmcnt(0)
    v_max3_f32 v5, v192, v194, v196
    v_max3_f32 v5, v5, v198, v200
    v_max3_f32 v5, v5, v202, v204
    v_max_f32 v5, v5, v206
    v_sub_f32 v192, v192, v5
    v_mul_f32 v192, s43, v192
    v_exp_f32 v192, v192
    v_sub_f32 v194, v194, v5
    v_mul_f32 v194, s43, v194
    v_exp_f32 v194, v194
    v_sub_f32 v196, v196, v5
    v_mul_f32 v196, s43, v196
    v_exp_f32 v196, v196
    v_sub_f32 v198, v198, v5
    v_mul_f32 v198, s43, v198
    v_exp_f32 v198, v198
    v_sub_f32 v200, v200, v5
    v_mul_f32 v200, s43, v200
    v_exp_f32 v200, v200
    v_sub_f32 v202, v202, v5
    v_mul_f32 v202, s43, v202
    v_exp_f32 v202, v202
    v_sub_f32 v204, v204, v5
    v_mul_f32 v204, s43, v204
    v_exp_f32 v204, v204
    v_sub_f32 v206, v206, v5
    v_mul_f32 v206, s43, v206
    v_exp_f32 v206, v206
    s_nop 0
    v_mul_f32 v6, v192, v16
    v_mul_f32 v8, v192, v17
    v_mul_f32 v12, v192, v193
    v_fmac_f32 v6, v194, v18
    v_fmac_f32 v8, v194, v19
    v_fmac_f32 v12, v194, v195
    v_fmac_f32 v6, v196, v20
    v_fmac_f32 v8, v196, v21
    v_fmac_f32 v12, v196, v197
    v_fmac_f32 v6, v198, v22
    v_fmac_f32 v8, v198, v23
    v_fmac_f32 v12, v198, v199
    v_fmac_f32 v6, v200, v24
    v_fmac_f32 v8, v200, v25
    v_fmac_f32 v12, v200, v201
    v_fmac_f32 v6, v202, v26
    v_fmac_f32 v8, v202, v27
    v_fmac_f32 v12, v202, v203
    v_fmac_f32 v6, v204, v28
    v_fmac_f32 v8, v204, v29
    v_fmac_f32 v12, v204, v205
    v_fmac_f32 v6, v206, v30
    v_fmac_f32 v8, v206, v31
    v_fmac_f32 v12, v206, v207
    v_mov_b32 v7, s42
    v_mov_b32 v9, s42
    buffer_store_dwordx4 v[6:9], v2, s[60:63], s74 offen sc0 sc1
    v_mov_b32 v10, v5
    v_mov_b32 v11, s42
    v_mov_b32 v13, s42
    v_mov_b32 v4, 0
    s_mov_b64 s[94:95], exec
    s_mov_b64 exec, 1
    buffer_store_dwordx4 v[10:13], v4, s[60:63], s75 offen sc0 sc1
    s_mov_b64 exec, s[94:95]
    s_nop 1
    s_add_u32 s74, s74, 16384
    s_add_u32 s75, s75, 256
    v_lshlrev_b32 v3, 3, v1
    v_mov_b32 v4, 0
    ds_read_b64 v[16:17], v3 offset:1536
    ds_read_b64 v[18:19], v3 offset:3584
    ds_read_b64 v[20:21], v3 offset:5632
    ds_read_b64 v[22:23], v3 offset:7680
    ds_read_b64 v[24:25], v3 offset:9728
    ds_read_b64 v[26:27], v3 offset:11776
    ds_read_b64 v[28:29], v3 offset:13824
    ds_read_b64 v[30:31], v3 offset:15872
    ds_read_b128 v[192:195], v4 offset:18176
    ds_read_b128 v[196:199], v4 offset:18192
    ds_read_b128 v[200:203], v4 offset:18208
    ds_read_b128 v[204:207], v4 offset:18224
    s_waitcnt lgkmcnt(0)
    v_max3_f32 v5, v192, v194, v196
    v_max3_f32 v5, v5, v198, v200
    v_max3_f32 v5, v5, v202, v204
    v_max_f32 v5, v5, v206
    v_sub_f32 v192, v192, v5
    v_mul_f32 v192, s43, v192
    v_exp_f32 v192, v192
    v_sub_f32 v194, v194, v5
    v_mul_f32 v194, s43, v194
    v_exp_f32 v194, v194
    v_sub_f32 v196, v196, v5
    v_mul_f32 v196, s43, v196
    v_exp_f32 v196, v196
    v_sub_f32 v198, v198, v5
    v_mul_f32 v198, s43, v198
    v_exp_f32 v198, v198
    v_sub_f32 v200, v200, v5
    v_mul_f32 v200, s43, v200
    v_exp_f32 v200, v200
    v_sub_f32 v202, v202, v5
    v_mul_f32 v202, s43, v202
    v_exp_f32 v202, v202
    v_sub_f32 v204, v204, v5
    v_mul_f32 v204, s43, v204
    v_exp_f32 v204, v204
    v_sub_f32 v206, v206, v5
    v_mul_f32 v206, s43, v206
    v_exp_f32 v206, v206
    s_nop 0
    v_mul_f32 v6, v192, v16
    v_mul_f32 v8, v192, v17
    v_mul_f32 v12, v192, v193
    v_fmac_f32 v6, v194, v18
    v_fmac_f32 v8, v194, v19
    v_fmac_f32 v12, v194, v195
    v_fmac_f32 v6, v196, v20
    v_fmac_f32 v8, v196, v21
    v_fmac_f32 v12, v196, v197
    v_fmac_f32 v6, v198, v22
    v_fmac_f32 v8, v198, v23
    v_fmac_f32 v12, v198, v199
    v_fmac_f32 v6, v200, v24
    v_fmac_f32 v8, v200, v25
    v_fmac_f32 v12, v200, v201
    v_fmac_f32 v6, v202, v26
    v_fmac_f32 v8, v202, v27
    v_fmac_f32 v12, v202, v203
    v_fmac_f32 v6, v204, v28
    v_fmac_f32 v8, v204, v29
    v_fmac_f32 v12, v204, v205
    v_fmac_f32 v6, v206, v30
    v_fmac_f32 v8, v206, v31
    v_fmac_f32 v12, v206, v207
    v_mov_b32 v7, s42
    v_mov_b32 v9, s42
    buffer_store_dwordx4 v[6:9], v2, s[60:63], s74 offen sc0 sc1
    v_mov_b32 v10, v5
    v_mov_b32 v11, s42
    v_mov_b32 v13, s42
    v_mov_b32 v4, 0
    s_mov_b64 s[94:95], exec
    s_mov_b64 exec, 1
    buffer_store_dwordx4 v[10:13], v4, s[60:63], s75 offen sc0 sc1
    s_mov_b64 exec, s[94:95]
    s_nop 1
L_amerged_29:
    s_nop 2
    s_setprio 0
    s_setprio 1
    s_mov_b32 s64, s34
    s_and_b32 s65, s35, 0xffff
    s_mov_b32 s66, 0x400000
    s_mov_b32 s67, 0x00020000
    v_and_b32 v3, 3, v1
    v_lshlrev_b32 v3, 12, v3
    v_lshrrev_b32 v4, 2, v1
    v_and_b32 v4, 7, v4
    v_lshl_add_u32 v3, v4, 4, v3
    s_lshl_b32 s4, s72, 17
    s_lshl_b32 s5, s3, 14
    s_add_u32 s4, s4, s5
    s_lshl_b32 s5, s73, 7
    s_add_u32 s4, s4, s5
    buffer_load_dwordx4 v[208:211], v3, s[64:67], s4 offen offset:0 nt
    buffer_load_dwordx4 v[212:215], v3, s[64:67], s4 offen offset:1024 nt
    buffer_load_dwordx4 v[216:219], v3, s[64:67], s4 offen offset:2048 nt
    buffer_load_dwordx4 v[220:223], v3, s[64:67], s4 offen offset:3072 nt
    s_setprio 0
L_bloop:
    s_nop 2
    v_mov_b32 v25, 17920
    v_mov_b32 v24, 1
    s_mov_b64 s[94:95], exec
    s_mov_b64 exec, 1
    ds_add_rtn_u32 v26, v25, v24
    s_mov_b64 exec, s[94:95]
    s_cmp_eq_u32 s85, s87
    s_cbranch_scc1 L_noswap_30
    v_swap_b32 v32, v36
    v_swap_b32 v33, v37
    v_swap_b32 v34, v38
    v_swap_b32 v35, v39
    v_swap_b32 v40, v48
    v_swap_b32 v41, v49
    v_swap_b32 v42, v50
    v_swap_b32 v43, v51
    v_swap_b32 v44, v52
    v_swap_b32 v45, v53
    v_swap_b32 v46, v54
    v_swap_b32 v47, v55
    v_swap_b32 v56, v58
    v_swap_b32 v57, v59
    s_mov_b32 s87, s85
    s_mov_b32 s99, 1
L_noswap_30:
    s_nop 2
    s_waitcnt vmcnt(12)
    v_dot2_f32_bf16 v3, v128, v32, 0
    v_dot2_f32_bf16 v4, v132, v32, 0
    v_dot2_f32_bf16 v5, v136, v32, 0
    v_dot2_f32_bf16 v6, v140, v32, 0
    v_dot2_f32_bf16 v3, v129, v33, v3
    v_dot2_f32_bf16 v4, v133, v33, v4
    v_dot2_f32_bf16 v5, v137, v33, v5
    v_dot2_f32_bf16 v6, v141, v33, v6
    v_dot2_f32_bf16 v3, v130, v34, v3
    v_dot2_f32_bf16 v4, v134, v34, v4
    v_dot2_f32_bf16 v5, v138, v34, v5
    v_dot2_f32_bf16 v6, v142, v34, v6
    v_dot2_f32_bf16 v3, v131, v35, v3
    v_dot2_f32_bf16 v4, v135, v35, v4
    v_dot2_f32_bf16 v5, v139, v35, v5
    v_dot2_f32_bf16 v6, v143, v35, v6
    s_waitcnt lgkmcnt(0)
    v_readfirstlane_b32 s74, v26
    s_nop 3
    s_mov_b32 s101, s74
    s_lshr_b32 s75, s74, 3
    s_and_b32 s76, s74, 7
    s_cmp_lt_u32 s74, 192
    s_cbranch_scc1 L_stat_32
    s_sub_u32 s74, s74, 192
    s_lshr_b32 s75, s74, 3
    s_and_b32 s76, s74, 7
    s_min_u32 s75, s75, 300
    s_cmp_lg_u32 s76, 0
    s_cbranch_scc1 L_norq_31
    s_add_u32 s89, s75, 1
    s_mov_b32 s90, 1
    s_mov_b32 s91, 0
    s_atomic_add_x2 s[90:91], s[92:93], 0 glc
    s_cmp_eq_u32 s89, 0
    s_cbranch_scc1 L_noreq_34
    s_waitcnt lgkmcnt(0)
    s_mov_b32 s96, 0
L_rqretry_35:
    s_nop 2
    s_cmp_eq_u32 s91, s42
    s_cbranch_scc1 L_rqok_36
    s_sleep 8
    s_mov_b32 s90, 1
    s_mov_b32 s91, 0
    s_atomic_add_x2 s[90:91], s[92:93], 0 glc
    s_waitcnt lgkmcnt(0)
    s_add_u32 s96, s96, 1
    s_cmp_lt_u32 s96, 0x20000
    s_cbranch_scc1 L_rqretry_35
L_rqok_36:
    s_nop 2
    s_sub_u32 s4, s89, 1
    s_lshl_b32 s4, s4, 2
    v_mov_b32 v24, s4
    v_mov_b32 v25, s90
    ds_write_b32 v24, v25 offset:19392
    s_mov_b32 s89, 0
L_noreq_34:
    s_nop 2
L_norq_31:
    s_nop 2
    s_lshl_b32 s4, s75, 2
    v_mov_b32 v24, s4
    s_mov_b32 s96, 0
L_dspin_37:
    s_nop 2
    ds_read_b32 v25, v24 offset:19392
    s_waitcnt lgkmcnt(0)
    v_readfirstlane_b32 s77, v25
    s_nop 3
    s_add_u32 s96, s96, 1
    s_cmp_ge_u32 s96, 0x400000
    s_cbranch_scc1 L_dgot_38
    s_cmp_eq_u32 s77, -1
    s_cbranch_scc1 L_dspin_37
L_dgot_38:
    s_nop 2
    s_min_u32 s77, s77, 4096
    s_add_u32 s77, s77, 192
    s_branch L_gotg_33
L_stat_32:
    s_nop 2
    s_lshl_b32 s77, s75, 3
    s_add_u32 s77, s77, s73
L_gotg_33:
    s_nop 2
    s_cmp_ge_u32 s77, 256
    s_cbranch_scc1 L_drain0
    s_and_b32 s4, s77, 7
    s_lshr_b32 s78, s4, 2
    s_lshl_b32 s5, s78, 5
    s_add_u32 s5, s5, s72
    s_lshl_b32 s5, s5, 22
    s_and_b32 s4, s4, 3
    s_lshl_b32 s4, s4, 20
    s_add_u32 s5, s5, s4
    s_lshr_b32 s4, s77, 3
    s_lshl_b32 s4, s4, 15
    s_add_u32 s5, s5, s4
    s_lshl_b32 s4, s76, 12
    s_add_u32 s83, s5, s4
    buffer_load_dwordx4 v[128:131], v2, s[52:55], s83 offen offset:0 nt
    buffer_load_dwordx4 v[132:135], v2, s[52:55], s83 offen offset:1024 nt
    buffer_load_dwordx4 v[136:139], v2, s[52:55], s83 offen offset:2048 nt
    buffer_load_dwordx4 v[140:143], v2, s[52:55], s83 offen offset:3072 nt
    v_add_f32_dpp v7, v3, v3 row_ror:8 row_mask:0xf bank_mask:0x3
    v_add_f32_dpp v7, v4, v4 row_ror:8 row_mask:0xf bank_mask:0xc
    v_add_f32_dpp v8, v5, v5 row_ror:8 row_mask:0xf bank_mask:0x3
    v_add_f32_dpp v8, v6, v6 row_ror:8 row_mask:0xf bank_mask:0xc
    v_add_f32_dpp v9, v7, v7 row_half_mirror row_mask:0xf bank_mask:0x5
    s_nop 0
    v_add_f32_dpp v9, v8, v8 row_half_mirror row_mask:0xf bank_mask:0xa
    s_nop 1
    v_add_f32_dpp v9, v9, v9 quad_perm:[1,0,3,2] row_mask:0xf bank_mask:0xf
    s_nop 1
    v_add_f32_dpp v9, v9, v9 quad_perm:[2,3,0,1] row_mask:0xf bank_mask:0xf
    s_nop 1
    v_max_f32_dpp v10, v9, v9 row_half_mirror row_mask:0xf bank_mask:0xf
    s_nop 1
    v_max_f32_dpp v10, v10, v10 row_ror:8 row_mask:0xf bank_mask:0xf
    v_max_f32 v10, v10, v56
    v_sub_f32 v12, v56, v10
    v_mul_f32 v13, s43, v10
    v_mul_f32 v12, s43, v12
    v_fma_f32 v13, v9, s43, -v13
    v_exp_f32 v11, v12
    v_exp_f32 v13, v13
    v_mov_b32 v56, v10
    v_cvt_pk_bf16_f32 v14, v13, 0
    v_lshlrev_b32 v15, 16, v14
    v_mul_f32 v40, v11, v40
    v_mul_f32 v41, v11, v41
    v_mul_f32 v42, v11, v42
    v_mul_f32 v43, v11, v43
    v_mul_f32 v44, v11, v44
    v_mul_f32 v45, v11, v45
    v_mul_f32 v46, v11, v46
    v_mul_f32 v47, v11, v47
    v_fma_f32 v57, v57, v11, v15
    s_waitcnt vmcnt(12)
    v_dot2c_f32_bf16_dpp v40, v14, v144 row_newbcast:0 row_mask:0xf bank_mask:0xf
    v_dot2c_f32_bf16_dpp v41, v15, v144 row_newbcast:0 row_mask:0xf bank_mask:0xf
    v_dot2c_f32_bf16_dpp v42, v14, v145 row_newbcast:0 row_mask:0xf bank_mask:0xf
    v_dot2c_f32_bf16_dpp v43, v15, v145 row_newbcast:0 row_mask:0xf bank_mask:0xf
    v_dot2c_f32_bf16_dpp v44, v14, v146 row_newbcast:0 row_mask:0xf bank_mask:0xf
    v_dot2c_f32_bf16_dpp v45, v15, v146 row_newbcast:0 row_mask:0xf bank_mask:0xf
    v_dot2c_f32_bf16_dpp v46, v14, v147 row_newbcast:0 row_mask:0xf bank_mask:0xf
    v_dot2c_f32_bf16_dpp v47, v15, v147 row_newbcast:0 row_mask:0xf bank_mask:0xf
    v_dot2c_f32_bf16_dpp v40, v14, v148 row_newbcast:8 row_mask:0xf bank_mask:0xf
    v_dot2c_f32_bf16_dpp v41, v15, v148 row_newbcast:8 row_mask:0xf bank_mask:0xf
    v_dot2c_f32_bf16_dpp v42, v14, v149 row_newbcast:8 row_mask:0xf bank_mask:0xf
    v_dot2c_f32_bf16_dpp v43, v15, v149 row_newbcast:8 row_mask:0xf bank_mask:0xf
    v_dot2c_f32_bf16_dpp v44, v14, v150 row_newbcast:8 row_mask:0xf bank_mask:0xf
    v_dot2c_f32_bf16_dpp v45, v15, v150 row_newbcast:8 row_mask:0xf bank_mask:0xf
    v_dot2c_f32_bf16_dpp v46, v14, v151 row_newbcast:8 row_mask:0xf bank_mask:0xf
    v_dot2c_f32_bf16_dpp v47, v15, v151 row_newbcast:8 row_mask:0xf bank_mask:0xf
    v_dot2c_f32_bf16_dpp v40, v14, v152 row_newbcast:4 row_mask:0xf bank_mask:0xf
    v_dot2c_f32_bf16_dpp v41, v15, v152 row_newbcast:4 row_mask:0xf bank_mask:0xf
    v_dot2c_f32_bf16_dpp v42, v14, v153 row_newbcast:4 row_mask:0xf bank_mask:0xf
    v_dot2c_f32_bf16_dpp v43, v15, v153 row_newbcast:4 row_mask:0xf bank_mask:0xf
    v_dot2c_f32_bf16_dpp v44, v14, v154 row_newbcast:4 row_mask:0xf bank_mask:0xf
    v_dot2c_f32_bf16_dpp v45, v15, v154 row_newbcast:4 row_mask:0xf bank_mask:0xf
    v_dot2c_f32_bf16_dpp v46, v14, v155 row_newbcast:4 row_mask:0xf bank_mask:0xf
    v_dot2c_f32_bf16_dpp v47, v15, v155 row_newbcast:4 row_mask:0xf bank_mask:0xf
    v_dot2c_f32_bf16_dpp v40, v14, v156 row_newbcast:12 row_mask:0xf bank_mask:0xf
    v_dot2c_f32_bf16_dpp v41, v15, v156 row_newbcast:12 row_mask:0xf bank_mask:0xf
    v_dot2c_f32_bf16_dpp v42, v14, v157 row_newbcast:12 row_mask:0xf bank_mask:0xf
    v_dot2c_f32_bf16_dpp v43, v15, v157 row_newbcast:12 row_mask:0xf bank_mask:0xf
    v_dot2c_f32_bf16_dpp v44, v14, v158 row_newbcast:12 row_mask:0xf bank_mask:0xf
    v_dot2c_f32_bf16_dpp v45, v15, v158 row_newbcast:12 row_mask:0xf bank_mask:0xf
    v_dot2c_f32_bf16_dpp v46, v14, v159 row_newbcast:12 row_mask:0xf bank_mask:0xf
    v_dot2c_f32_bf16_dpp v47, v15, v159 row_newbcast:12 row_mask:0xf bank_mask:0xf
    buffer_load_dwordx4 v[144:147], v2, s[56:59], s83 offen offset:0 nt
    buffer_load_dwordx4 v[148:151], v2, s[56:59], s83 offen offset:1024 nt
    buffer_load_dwordx4 v[152:155], v2, s[56:59], s83 offen offset:2048 nt
    buffer_load_dwordx4 v[156:159], v2, s[56:59], s83 offen offset:3072 nt
    s_mov_b32 s85, s78
    v_mov_b32 v25, 17920
    v_mov_b32 v24, 1
    s_mov_b64 s[94:95], exec
    s_mov_b64 exec, 1
    ds_add_rtn_u32 v26, v25, v24
    s_mov_b64 exec, s[94:95]
    s_cmp_eq_u32 s86, s87
    s_cbranch_scc1 L_noswap_39
    v_swap_b32 v32, v36
    v_swap_b32 v33, v37
    v_swap_b32 v34, v38
    v_swap_b32 v35, v39
    v_swap_b32 v40, v48
    v_swap_b32 v41, v49
    v_swap_b32 v42, v50
    v_swap_b32 v43, v51
    v_swap_b32 v44, v52
    v_swap_b32 v45, v53
    v_swap_b32 v46, v54
    v_swap_b32 v47, v55
    v_swap_b32 v56, v58
    v_swap_b32 v57, v59
    s_mov_b32 s87, s86
    s_mov_b32 s99, 1
L_noswap_39:
    s_nop 2
    s_waitcnt vmcnt(12)
    v_dot2_f32_bf16 v3, v160, v32, 0
    v_dot2_f32_bf16 v4, v164, v32, 0
    v_dot2_f32_bf16 v5, v168, v32, 0
    v_dot2_f32_bf16 v6, v172, v32, 0
    v_dot2_f32_bf16 v3, v161, v33, v3
    v_dot2_f32_bf16 v4, v165, v33, v4
    v_dot2_f32_bf16 v5, v169, v33, v5
    v_dot2_f32_bf16 v6, v173, v33, v6
    v_dot2_f32_bf16 v3, v162, v34, v3
    v_dot2_f32_bf16 v4, v166, v34, v4
    v_dot2_f32_bf16 v5, v170, v34, v5
    v_dot2_f32_bf16 v6, v174, v34, v6
    v_dot2_f32_bf16 v3, v163, v35, v3
    v_dot2_f32_bf16 v4, v167, v35, v4
    v_dot2_f32_bf16 v5, v171, v35, v5
    v_dot2_f32_bf16 v6, v175, v35, v6
    s_waitcnt lgkmcnt(0)
    v_readfirstlane_b32 s74, v26
    s_nop 3
    s_mov_b32 s101, s74
    s_lshr_b32 s75, s74, 3
    s_and_b32 s76, s74, 7
    s_cmp_lt_u32 s74, 192
    s_cbranch_scc1 L_stat_41
    s_sub_u32 s74, s74, 192
    s_lshr_b32 s75, s74, 3
    s_and_b32 s76, s74, 7
    s_min_u32 s75, s75, 300
    s_cmp_lg_u32 s76, 0
    s_cbranch_scc1 L_norq_40
    s_add_u32 s89, s75, 1
    s_mov_b32 s90, 1
    s_mov_b32 s91, 0
    s_atomic_add_x2 s[90:91], s[92:93], 0 glc
    s_cmp_eq_u32 s89, 0
    s_cbranch_scc1 L_noreq_43
    s_waitcnt lgkmcnt(0)
    s_mov_b32 s96, 0
L_rqretry_44:
    s_nop 2
    s_cmp_eq_u32 s91, s42
    s_cbranch_scc1 L_rqok_45
    s_sleep 8
    s_mov_b32 s90, 1
    s_mov_b32 s91, 0
    s_atomic_add_x2 s[90:91], s[92:93], 0 glc
    s_waitcnt lgkmcnt(0)
    s_add_u32 s96, s96, 1
    s_cmp_lt_u32 s96, 0x20000
    s_cbranch_scc1 L_rqretry_44
L_rqok_45:
    s_nop 2
    s_sub_u32 s4, s89, 1
    s_lshl_b32 s4, s4, 2
    v_mov_b32 v24, s4
    v_mov_b32 v25, s90
    ds_write_b32 v24, v25 offset:19392
    s_mov_b32 s89, 0
L_noreq_43:
    s_nop 2
L_norq_40:
    s_nop 2
    s_lshl_b32 s4, s75, 2
    v_mov_b32 v24, s4
    s_mov_b32 s96, 0
L_dspin_46:
    s_nop 2
    ds_read_b32 v25, v24 offset:19392
    s_waitcnt lgkmcnt(0)
    v_readfirstlane_b32 s77, v25
    s_nop 3
    s_add_u32 s96, s96, 1
    s_cmp_ge_u32 s96, 0x400000
    s_cbranch_scc1 L_dgot_47
    s_cmp_eq_u32 s77, -1
    s_cbranch_scc1 L_dspin_46
L_dgot_47:
    s_nop 2
    s_min_u32 s77, s77, 4096
    s_add_u32 s77, s77, 192
    s_branch L_gotg_42
L_stat_41:
    s_nop 2
    s_lshl_b32 s77, s75, 3
    s_add_u32 s77, s77, s73
L_gotg_42:
    s_nop 2
    s_cmp_ge_u32 s77, 256
    s_cbranch_scc1 L_drain1
    s_and_b32 s4, s77, 7
    s_lshr_b32 s78, s4, 2
    s_lshl_b32 s5, s78, 5
    s_add_u32 s5, s5, s72
    s_lshl_b32 s5, s5, 22
    s_and_b32 s4, s4, 3
    s_lshl_b32 s4, s4, 20
    s_add_u32 s5, s5, s4
    s_lshr_b32 s4, s77, 3
    s_lshl_b32 s4, s4, 15
    s_add_u32 s5, s5, s4
    s_lshl_b32 s4, s76, 12
    s_add_u32 s84, s5, s4
    buffer_load_dwordx4 v[160:163], v2, s[52:55], s84 offen offset:0 nt
    buffer_load_dwordx4 v[164:167], v2, s[52:55], s84 offen offset:1024 nt
    buffer_load_dwordx4 v[168:171], v2, s[52:55], s84 offen offset:2048 nt
    buffer_load_dwordx4 v[172:175], v2, s[52:55], s84 offen offset:3072 nt
    v_add_f32_dpp v7, v3, v3 row_ror:8 row_mask:0xf bank_mask:0x3
    v_add_f32_dpp v7, v4, v4 row_ror:8 row_mask:0xf bank_mask:0xc
    v_add_f32_dpp v8, v5, v5 row_ror:8 row_mask:0xf bank_mask:0x3
    v_add_f32_dpp v8, v6, v6 row_ror:8 row_mask:0xf bank_mask:0xc
    v_add_f32_dpp v9, v7, v7 row_half_mirror row_mask:0xf bank_mask:0x5
    s_nop 0
    v_add_f32_dpp v9, v8, v8 row_half_mirror row_mask:0xf bank_mask:0xa
    s_nop 1
    v_add_f32_dpp v9, v9, v9 quad_perm:[1,0,3,2] row_mask:0xf bank_mask:0xf
    s_nop 1
    v_add_f32_dpp v9, v9, v9 quad_perm:[2,3,0,1] row_mask:0xf bank_mask:0xf
    s_nop 1
    v_max_f32_dpp v10, v9, v9 row_half_mirror row_mask:0xf bank_mask:0xf
    s_nop 1
    v_max_f32_dpp v10, v10, v10 row_ror:8 row_mask:0xf bank_mask:0xf
    v_max_f32 v10, v10, v56
    v_sub_f32 v12, v56, v10
    v_mul_f32 v13, s43, v10
    v_mul_f32 v12, s43, v12
    v_fma_f32 v13, v9, s43, -v13
    v_exp_f32 v11, v12
    v_exp_f32 v13, v13
    v_mov_b32 v56, v10
    v_cvt_pk_bf16_f32 v14, v13, 0
    v_lshlrev_b32 v15, 16, v14
    v_mul_f32 v40, v11, v40
    v_mul_f32 v41, v11, v41
    v_mul_f32 v42, v11, v42
    v_mul_f32 v43, v11, v43
    v_mul_f32 v44, v11, v44
    v_mul_f32 v45, v11, v45
    v_mul_f32 v46, v11, v46
    v_mul_f32 v47, v11, v47
    v_fma_f32 v57, v57, v11, v15
    s_waitcnt vmcnt(12)
    v_dot2c_f32_bf16_dpp v40, v14, v176 row_newbcast:0 row_mask:0xf bank_mask:0xf
    v_dot2c_f32_bf16_dpp v41, v15, v176 row_newbcast:0 row_mask:0xf bank_mask:0xf
    v_dot2c_f32_bf16_dpp v42, v14, v177 row_newbcast:0 row_mask:0xf bank_mask:0xf
    v_dot2c_f32_bf16_dpp v43, v15, v177 row_newbcast:0 row_mask:0xf bank_mask:0xf
    v_dot2c_f32_bf16_dpp v44, v14, v178 row_newbcast:0 row_mask:0xf bank_mask:0xf
    v_dot2c_f32_bf16_dpp v45, v15, v178 row_newbcast:0 row_mask:0xf bank_mask:0xf
    v_dot2c_f32_bf16_dpp v46, v14, v179 row_newbcast:0 row_mask:0xf bank_mask:0xf
    v_dot2c_f32_bf16_dpp v47, v15, v179 row_newbcast:0 row_mask:0xf bank_mask:0xf
    v_dot2c_f32_bf16_dpp v40, v14, v180 row_newbcast:8 row_mask:0xf bank_mask:0xf
    v_dot2c_f32_bf16_dpp v41, v15, v180 row_newbcast:8 row_mask:0xf bank_mask:0xf
    v_dot2c_f32_bf16_dpp v42, v14, v181 row_newbcast:8 row_mask:0xf bank_mask:0xf
    v_dot2c_f32_bf16_dpp v43, v15, v181 row_newbcast:8 row_mask:0xf bank_mask:0xf
    v_dot2c_f32_bf16_dpp v44, v14, v182 row_newbcast:8 row_mask:0xf bank_mask:0xf
    v_dot2c_f32_bf16_dpp v45, v15, v182 row_newbcast:8 row_mask:0xf bank_mask:0xf
    v_dot2c_f32_bf16_dpp v46, v14, v183 row_newbcast:8 row_mask:0xf bank_mask:0xf
    v_dot2c_f32_bf16_dpp v47, v15, v183 row_newbcast:8 row_mask:0xf bank_mask:0xf
    v_dot2c_f32_bf16_dpp v40, v14, v184 row_newbcast:4 row_mask:0xf bank_mask:0xf
    v_dot2c_f32_bf16_dpp v41, v15, v184 row_newbcast:4 row_mask:0xf bank_mask:0xf
    v_dot2c_f32_bf16_dpp v42, v14, v185 row_newbcast:4 row_mask:0xf bank_mask:0xf
    v_dot2c_f32_bf16_dpp v43, v15, v185 row_newbcast:4 row_mask:0xf bank_mask:0xf
    v_dot2c_f32_bf16_dpp v44, v14, v186 row_newbcast:4 row_mask:0xf bank_mask:0xf
    v_dot2c_f32_bf16_dpp v45, v15, v186 row_newbcast:4 row_mask:0xf bank_mask:0xf
    v_dot2c_f32_bf16_dpp v46, v14, v187 row_newbcast:4 row_mask:0xf bank_mask:0xf
    v_dot2c_f32_bf16_dpp v47, v15, v187 row_newbcast:4 row_mask:0xf bank_mask:0xf
    v_dot2c_f32_bf16_dpp v40, v14, v188 row_newbcast:12 row_mask:0xf bank_mask:0xf
    v_dot2c_f32_bf16_dpp v41, v15, v188 row_newbcast:12 row_mask:0xf bank_mask:0xf
    v_dot2c_f32_bf16_dpp v42, v14, v189 row_newbcast:12 row_mask:0xf bank_mask:0xf
    v_dot2c_f32_bf16_dpp v43, v15, v189 row_newbcast:12 row_mask:0xf bank_mask:0xf
    v_dot2c_f32_bf16_dpp v44, v14, v190 row_newbcast:12 row_mask:0xf bank_mask:0xf
    v_dot2c_f32_bf16_dpp v45, v15, v190 row_newbcast:12 row_mask:0xf bank_mask:0xf
    v_dot2c_f32_bf16_dpp v46, v14, v191 row_newbcast:12 row_mask:0xf bank_mask:0xf
    v_dot2c_f32_bf16_dpp v47, v15, v191 row_newbcast:12 row_mask:0xf bank_mask:0xf
    buffer_load_dwordx4 v[176:179], v2, s[56:59], s84 offen offset:0 nt
    buffer_load_dwordx4 v[180:183], v2, s[56:59], s84 offen offset:1024 nt
    buffer_load_dwordx4 v[184:187], v2, s[56:59], s84 offen offset:2048 nt
    buffer_load_dwordx4 v[188:191], v2, s[56:59], s84 offen offset:3072 nt
    s_mov_b32 s86, s78
    s_add_u32 s88, s88, 1
    s_cmp_lg_u32 s100, 0
    s_cbranch_scc1 L_st4_50
    s_cmp_lt_u32 s101, 56
    s_cbranch_scc1 L_noside_48
    v_mov_b32 v25, 17952
    v_mov_b32 v24, 1
    s_mov_b64 s[94:95], exec
    s_mov_b64 exec, 1
    ds_add_rtn_u32 v24, v25, v24
    s_mov_b64 exec, s[94:95]
    s_waitcnt lgkmcnt(0)
    v_readfirstlane_b32 s4, v24
    s_nop 3
    s_cmp_lg_u32 s4, 0
    s_cbranch_scc1 L_nol1_51
    s_setprio 2
    v_lshrrev_b32 v3, 5, v1
    v_lshrrev_b32 v4, 2, v1
    v_and_b32 v4, 7, v4
    v_lshlrev_b32 v3, 9, v3
    v_add_u32 v3, v3, v4
    s_lshl_b32 s74, s72, 4
    v_add_u32 v3, s74, v3
    v_lshlrev_b32 v5, 4, v3
    v_lshlrev_b32 v6, 10, v3
    v_and_b32 v4, 3, v1
    v_lshl_add_u32 v6, v4, 5, v6
    s_lshl_b32 s74, s73, 7
    s_add_u32 s74, s74, 0x100000
    s_mov_b32 s75, 0x20000
    s_add_u32 s76, s74, 8192
    s_add_u32 s77, s75, 128
    buffer_load_dwordx4 v[224:227], v6, s[60:63], s74 offen sc0 sc1
    buffer_load_dwordx4 v[228:231], v6, s[60:63], s74 offen offset:16 sc0 sc1
    buffer_load_dwordx4 v[232:235], v5, s[60:63], s75 offen sc0 sc1
    buffer_load_dwordx4 v[236:239], v6, s[60:63], s76 offen sc0 sc1
    buffer_load_dwordx4 v[240:243], v6, s[60:63], s76 offen offset:16 sc0 sc1
    buffer_load_dwordx4 v[244:247], v5, s[60:63], s77 offen sc0 sc1
    s_mov_b32 s100, 32
    v_mov_b32 v25, 17920
    v_mov_b32 v24, 1
    s_mov_b64 s[94:95], exec
    s_mov_b64 exec, 1
    ds_add_rtn_u32 v26, v25, v24
    s_mov_b64 exec, s[94:95]
    s_cmp_eq_u32 s85, s87
    s_cbranch_scc1 L_noswap_52
    v_swap_b32 v32, v36
    v_swap_b32 v33, v37
    v_swap_b32 v34, v38
    v_swap_b32 v35, v39
    v_swap_b32 v40, v48
    v_swap_b32 v41, v49
    v_swap_b32 v42, v50
    v_swap_b32 v43, v51
    v_swap_b32 v44, v52
    v_swap_b32 v45, v53
    v_swap_b32 v46, v54
    v_swap_b32 v47, v55
    v_swap_b32 v56, v58
    v_swap_b32 v57, v59
    s_mov_b32 s87, s85
    s_mov_b32 s99, 1
L_noswap_52:
    s_nop 2
    s_waitcnt vmcnt(18)
    v_dot2_f32_bf16 v3, v128, v32, 0
    v_dot2_f32_bf16 v4, v132, v32, 0
    v_dot2_f32_bf16 v5, v136, v32, 0
    v_dot2_f32_bf16 v6, v140, v32, 0
    v_dot2_f32_bf16 v3, v129, v33, v3
    v_dot2_f32_bf16 v4, v133, v33, v4
    v_dot2_f32_bf16 v5, v137, v33, v5
    v_dot2_f32_bf16 v6, v141, v33, v6
    v_dot2_f32_bf16 v3, v130, v34, v3
    v_dot2_f32_bf16 v4, v134, v34, v4
    v_dot2_f32_bf16 v5, v138, v34, v5
    v_dot2_f32_bf16 v6, v142, v34, v6
    v_dot2_f32_bf16 v3, v131, v35, v3
    v_dot2_f32_bf16 v4, v135, v35, v4
    v_dot2_f32_bf16 v5, v139, v35, v5
    v_dot2_f32_bf16 v6, v143, v35, v6
    s_waitcnt lgkmcnt(0)
    v_readfirstlane_b32 s74, v26
    s_nop 3
    s_mov_b32 s101, s74
    s_lshr_b32 s75, s74, 3
    s_and_b32 s76, s74, 7
    s_cmp_lt_u32 s74, 192
    s_cbranch_scc1 L_stat_54
    s_sub_u32 s74, s74, 192
    s_lshr_b32 s75, s74, 3
    s_and_b32 s76, s74, 7
    s_min_u32 s75, s75, 300
    s_cmp_lg_u32 s76, 0
    s_cbranch_scc1 L_norq_53
    s_add_u32 s89, s75, 1
    s_mov_b32 s90, 1
    s_mov_b32 s91, 0
    s_atomic_add_x2 s[90:91], s[92:93], 0 glc
    s_cmp_eq_u32 s89, 0
    s_cbranch_scc1 L_noreq_56
    s_waitcnt lgkmcnt(0)
    s_mov_b32 s96, 0
L_rqretry_57:
    s_nop 2
    s_cmp_eq_u32 s91, s42
    s_cbranch_scc1 L_rqok_58
    s_sleep 8
    s_mov_b32 s90, 1
    s_mov_b32 s91, 0
    s_atomic_add_x2 s[90:91], s[92:93], 0 glc
    s_waitcnt lgkmcnt(0)
    s_add_u32 s96, s96, 1
    s_cmp_lt_u32 s96, 0x20000
    s_cbranch_scc1 L_rqretry_57
L_rqok_58:
    s_nop 2
    s_sub_u32 s4, s89, 1
    s_lshl_b32 s4, s4, 2
    v_mov_b32 v24, s4
    v_mov_b32 v25, s90
    ds_write_b32 v24, v25 offset:19392
    s_mov_b32 s89, 0
L_noreq_56:
    s_nop 2
L_norq_53:
    s_nop 2
    s_lshl_b32 s4, s75, 2
    v_mov_b32 v24, s4
    s_mov_b32 s96, 0
L_dspin_59:
    s_nop 2
    ds_read_b32 v25, v24 offset:19392
    s_waitcnt lgkmcnt(0)
    v_readfirstlane_b32 s77, v25
    s_nop 3
    s_add_u32 s96, s96, 1
    s_cmp_ge_u32 s96, 0x400000
    s_cbranch_scc1 L_dgot_60
    s_cmp_eq_u32 s77, -1
    s_cbranch_scc1 L_dspin_59
L_dgot_60:
    s_nop 2
    s_min_u32 s77, s77, 4096
    s_add_u32 s77, s77, 192
    s_branch L_gotg_55
L_stat_54:
    s_nop 2
    s_lshl_b32 s77, s75, 3
    s_add_u32 s77, s77, s73
L_gotg_55:
    s_nop 2
    s_cmp_ge_u32 s77, 256
    s_cbranch_scc1 L_drain0
    s_and_b32 s4, s77, 7
    s_lshr_b32 s78, s4, 2
    s_lshl_b32 s5, s78, 5
    s_add_u32 s5, s5, s72
    s_lshl_b32 s5, s5, 22
    s_and_b32 s4, s4, 3
    s_lshl_b32 s4, s4, 20
    s_add_u32 s5, s5, s4
    s_lshr_b32 s4, s77, 3
    s_lshl_b32 s4, s4, 15
    s_add_u32 s5, s5, s4
    s_lshl_b32 s4, s76, 12
    s_add_u32 s83, s5, s4
    buffer_load_dwordx4 v[128:131], v2, s[52:55], s83 offen offset:0 nt
    buffer_load_dwordx4 v[132:135], v2, s[52:55], s83 offen offset:1024 nt
    buffer_load_dwordx4 v[136:139], v2, s[52:55], s83 offen offset:2048 nt
    buffer_load_dwordx4 v[140:143], v2, s[52:55], s83 offen offset:3072 nt
    v_add_f32_dpp v7, v3, v3 row_ror:8 row_mask:0xf bank_mask:0x3
    v_add_f32_dpp v7, v4, v4 row_ror:8 row_mask:0xf bank_mask:0xc
    v_add_f32_dpp v8, v5, v5 row_ror:8 row_mask:0xf bank_mask:0x3
    v_add_f32_dpp v8, v6, v6 row_ror:8 row_mask:0xf bank_mask:0xc
    v_add_f32_dpp v9, v7, v7 row_half_mirror row_mask:0xf bank_mask:0x5
    s_nop 0
    v_add_f32_dpp v9, v8, v8 row_half_mirror row_mask:0xf bank_mask:0xa
    s_nop 1
    v_add_f32_dpp v9, v9, v9 quad_perm:[1,0,3,2] row_mask:0xf bank_mask:0xf
    s_nop 1
    v_add_f32_dpp v9, v9, v9 quad_perm:[2,3,0,1] row_mask:0xf bank_mask:0xf
    s_nop 1
    v_max_f32_dpp v10, v9, v9 row_half_mirror row_mask:0xf bank_mask:0xf
    s_nop 1
    v_max_f32_dpp v10, v10, v10 row_ror:8 row_mask:0xf bank_mask:0xf
    v_max_f32 v10, v10, v56
    v_sub_f32 v12, v56, v10
    v_mul_f32 v13, s43, v10
    v_mul_f32 v12, s43, v12
    v_fma_f32 v13, v9, s43, -v13
    v_exp_f32 v11, v12
    v_exp_f32 v13, v13
    v_mov_b32 v56, v10
    v_cvt_pk_bf16_f32 v14, v13, 0
    v_lshlrev_b32 v15, 16, v14
    v_mul_f32 v40, v11, v40
    v_mul_f32 v41, v11, v41
    v_mul_f32 v42, v11, v42
    v_mul_f32 v43, v11, v43
    v_mul_f32 v44, v11, v44
    v_mul_f32 v45, v11, v45
    v_mul_f32 v46, v11, v46
    v_mul_f32 v47, v11, v47
    v_fma_f32 v57, v57, v11, v15
    s_waitcnt vmcnt(18)
    v_dot2c_f32_bf16_dpp v40, v14, v144 row_newbcast:0 row_mask:0xf bank_mask:0xf
    v_dot2c_f32_bf16_dpp v41, v15, v144 row_newbcast:0 row_mask:0xf bank_mask:0xf
    v_dot2c_f32_bf16_dpp v42, v14, v145 row_newbcast:0 row_mask:0xf bank_mask:0xf
    v_dot2c_f32_bf16_dpp v43, v15, v145 row_newbcast:0 row_mask:0xf bank_mask:0xf
    v_dot2c_f32_bf16_dpp v44, v14, v146 row_newbcast:0 row_mask:0xf bank_mask:0xf
    v_dot2c_f32_bf16_dpp v45, v15, v146 row_newbcast:0 row_mask:0xf bank_mask:0xf
    v_dot2c_f32_bf16_dpp v46, v14, v147 row_newbcast:0 row_mask:0xf bank_mask:0xf
    v_dot2c_f32_bf16_dpp v47, v15, v147 row_newbcast:0 row_mask:0xf bank_mask:0xf
    v_dot2c_f32_bf16_dpp v40, v14, v148 row_newbcast:8 row_mask:0xf bank_mask:0xf
    v_dot2c_f32_bf16_dpp v41, v15, v148 row_newbcast:8 row_mask:0xf bank_mask:0xf
    v_dot2c_f32_bf16_dpp v42, v14, v149 row_newbcast:8 row_mask:0xf bank_mask:0xf
    v_dot2c_f32_bf16_dpp v43, v15, v149 row_newbcast:8 row_mask:0xf bank_mask:0xf
    v_dot2c_f32_bf16_dpp v44, v14, v150 row_newbcast:8 row_mask:0xf bank_mask:0xf
    v_dot2c_f32_bf16_dpp v45, v15, v150 row_newbcast:8 row_mask:0xf bank_mask:0xf
    v_dot2c_f32_bf16_dpp v46, v14, v151 row_newbcast:8 row_mask:0xf bank_mask:0xf
    v_dot2c_f32_bf16_dpp v47, v15, v151 row_newbcast:8 row_mask:0xf bank_mask:0xf
    v_dot2c_f32_bf16_dpp v40, v14, v152 row_newbcast:4 row_mask:0xf bank_mask:0xf
    v_dot2c_f32_bf16_dpp v41, v15, v152 row_newbcast:4 row_mask:0xf bank_mask:0xf
    v_dot2c_f32_bf16_dpp v42, v14, v153 row_newbcast:4 row_mask:0xf bank_mask:0xf
    v_dot2c_f32_bf16_dpp v43, v15, v153 row_newbcast:4 row_mask:0xf bank_mask:0xf
    v_dot2c_f32_bf16_dpp v44, v14, v154 row_newbcast:4 row_mask:0xf bank_mask:0xf
    v_dot2c_f32_bf16_dpp v45, v15, v154 row_newbcast:4 row_mask:0xf bank_mask:0xf
    v_dot2c_f32_bf16_dpp v46, v14, v155 row_newbcast:4 row_mask:0xf bank_mask:0xf
    v_dot2c_f32_bf16_dpp v47, v15, v155 row_newbcast:4 row_mask:0xf bank_mask:0xf
    v_dot2c_f32_bf16_dpp v40, v14, v156 row_newbcast:12 row_mask:0xf bank_mask:0xf
    v_dot2c_f32_bf16_dpp v41, v15, v156 row_newbcast:12 row_mask:0xf bank_mask:0xf
    v_dot2c_f32_bf16_dpp v42, v14, v157 row_newbcast:12 row_mask:0xf bank_mask:0xf
    v_dot2c_f32_bf16_dpp v43, v15, v157 row_newbcast:12 row_mask:0xf bank_mask:0xf
    v_dot2c_f32_bf16_dpp v44, v14, v158 row_newbcast:12 row_mask:0xf bank_mask:0xf
    v_dot2c_f32_bf16_dpp v45, v15, v158 row_newbcast:12 row_mask:0xf bank_mask:0xf
    v_dot2c_f32_bf16_dpp v46, v14, v159 row_newbcast:12 row_mask:0xf bank_mask:0xf
    v_dot2c_f32_bf16_dpp v47, v15, v159 row_newbcast:12 row_mask:0xf bank_mask:0xf
    buffer_load_dwordx4 v[144:147], v2, s[56:59], s83 offen offset:0 nt
    buffer_load_dwordx4 v[148:151], v2, s[56:59], s83 offen offset:1024 nt
    buffer_load_dwordx4 v[152:155], v2, s[56:59], s83 offen offset:2048 nt
    buffer_load_dwordx4 v[156:159], v2, s[56:59], s83 offen offset:3072 nt
    s_mov_b32 s85, s78
    v_mov_b32 v25, 17920
    v_mov_b32 v24, 1
    s_mov_b64 s[94:95], exec
    s_mov_b64 exec, 1
    ds_add_rtn_u32 v26, v25, v24
    s_mov_b64 exec, s[94:95]
    s_cmp_eq_u32 s86, s87
    s_cbranch_scc1 L_noswap_61
    v_swap_b32 v32, v36
    v_swap_b32 v33, v37
    v_swap_b32 v34, v38
    v_swap_b32 v35, v39
    v_swap_b32 v40, v48
    v_swap_b32 v41, v49
    v_swap_b32 v42, v50
    v_swap_b32 v43, v51
    v_swap_b32 v44, v52
    v_swap_b32 v45, v53
    v_swap_b32 v46, v54
    v_swap_b32 v47, v55
    v_swap_b32 v56, v58
    v_swap_b32 v57, v59
    s_mov_b32 s87, s86
    s_mov_b32 s99, 1
L_noswap_61:
    s_nop 2
    s_waitcnt vmcnt(18)
    v_dot2_f32_bf16 v3, v160, v32, 0
    v_dot2_f32_bf16 v4, v164, v32, 0
    v_dot2_f32_bf16 v5, v168, v32, 0
    v_dot2_f32_bf16 v6, v172, v32, 0
    v_dot2_f32_bf16 v3, v161, v33, v3
    v_dot2_f32_bf16 v4, v165, v33, v4
    v_dot2_f32_bf16 v5, v169, v33, v5
    v_dot2_f32_bf16 v6, v173, v33, v6
    v_dot2_f32_bf16 v3, v162, v34, v3
    v_dot2_f32_bf16 v4, v166, v34, v4
    v_dot2_f32_bf16 v5, v170, v34, v5
    v_dot2_f32_bf16 v6, v174, v34, v6
    v_dot2_f32_bf16 v3, v163, v35, v3
    v_dot2_f32_bf16 v4, v167, v35, v4
    v_dot2_f32_bf16 v5, v171, v35, v5
    v_dot2_f32_bf16 v6, v175, v35, v6
    s_waitcnt lgkmcnt(0)
    v_readfirstlane_b32 s74, v26
    s_nop 3
    s_mov_b32 s101, s74
    s_lshr_b32 s75, s74, 3
    s_and_b32 s76, s74, 7
    s_cmp_lt_u32 s74, 192
    s_cbranch_scc1 L_stat_63
    s_sub_u32 s74, s74, 192
    s_lshr_b32 s75, s74, 3
    s_and_b32 s76, s74, 7
    s_min_u32 s75, s75, 300
    s_cmp_lg_u32 s76, 0
    s_cbranch_scc1 L_norq_62
    s_add_u32 s89, s75, 1
    s_mov_b32 s90, 1
    s_mov_b32 s91, 0
    s_atomic_add_x2 s[90:91], s[92:93], 0 glc
    s_cmp_eq_u32 s89, 0
    s_cbranch_scc1 L_noreq_65
    s_waitcnt lgkmcnt(0)
    s_mov_b32 s96, 0
L_rqretry_66:
    s_nop 2
    s_cmp_eq_u32 s91, s42
    s_cbranch_scc1 L_rqok_67
    s_sleep 8
    s_mov_b32 s90, 1
    s_mov_b32 s91, 0
    s_atomic_add_x2 s[90:91], s[92:93], 0 glc
    s_waitcnt lgkmcnt(0)
    s_add_u32 s96, s96, 1
    s_cmp_lt_u32 s96, 0x20000
    s_cbranch_scc1 L_rqretry_66
L_rqok_67:
    s_nop 2
    s_sub_u32 s4, s89, 1
    s_lshl_b32 s4, s4, 2
    v_mov_b32 v24, s4
    v_mov_b32 v25, s90
    ds_write_b32 v24, v25 offset:19392
    s_mov_b32 s89, 0
L_noreq_65:
    s_nop 2
L_norq_62:
    s_nop 2
    s_lshl_b32 s4, s75, 2
    v_mov_b32 v24, s4
    s_mov_b32 s96, 0
L_dspin_68:
    s_nop 2
    ds_read_b32 v25, v24 offset:19392
    s_waitcnt lgkmcnt(0)
    v_readfirstlane_b32 s77, v25
    s_nop 3
    s_add_u32 s96, s96, 1
    s_cmp_ge_u32 s96, 0x400000
    s_cbranch_scc1 L_dgot_69
    s_cmp_eq_u32 s77, -1
    s_cbranch_scc1 L_dspin_68
L_dgot_69:
    s_nop 2
    s_min_u32 s77, s77, 4096
    s_add_u32 s77, s77, 192
    s_branch L_gotg_64
L_stat_63:
    s_nop 2
    s_lshl_b32 s77, s75, 3
    s_add_u32 s77, s77, s73
L_gotg_64:
    s_nop 2
    s_cmp_ge_u32 s77, 256
    s_cbranch_scc1 L_drain1
    s_and_b32 s4, s77, 7
    s_lshr_b32 s78, s4, 2
    s_lshl_b32 s5, s78, 5
    s_add_u32 s5, s5, s72
    s_lshl_b32 s5, s5, 22
    s_and_b32 s4, s4, 3
    s_lshl_b32 s4, s4, 20
    s_add_u32 s5, s5, s4
    s_lshr_b32 s4, s77, 3
    s_lshl_b32 s4, s4, 15
    s_add_u32 s5, s5, s4
    s_lshl_b32 s4, s76, 12
    s_add_u32 s84, s5, s4
    buffer_load_dwordx4 v[160:163], v2, s[52:55], s84 offen offset:0 nt
    buffer_load_dwordx4 v[164:167], v2, s[52:55], s84 offen offset:1024 nt
    buffer_load_dwordx4 v[168:171], v2, s[52:55], s84 offen offset:2048 nt
    buffer_load_dwordx4 v[172:175], v2, s[52:55], s84 offen offset:3072 nt
    v_add_f32_dpp v7, v3, v3 row_ror:8 row_mask:0xf bank_mask:0x3
    v_add_f32_dpp v7, v4, v4 row_ror:8 row_mask:0xf bank_mask:0xc
    v_add_f32_dpp v8, v5, v5 row_ror:8 row_mask:0xf bank_mask:0x3
    v_add_f32_dpp v8, v6, v6 row_ror:8 row_mask:0xf bank_mask:0xc
    v_add_f32_dpp v9, v7, v7 row_half_mirror row_mask:0xf bank_mask:0x5
    s_nop 0
    v_add_f32_dpp v9, v8, v8 row_half_mirror row_mask:0xf bank_mask:0xa
    s_nop 1
    v_add_f32_dpp v9, v9, v9 quad_perm:[1,0,3,2] row_mask:0xf bank_mask:0xf
    s_nop 1
    v_add_f32_dpp v9, v9, v9 quad_perm:[2,3,0,1] row_mask:0xf bank_mask:0xf
    s_nop 1
    v_max_f32_dpp v10, v9, v9 row_half_mirror row_mask:0xf bank_mask:0xf
    s_nop 1
    v_max_f32_dpp v10, v10, v10 row_ror:8 row_mask:0xf bank_mask:0xf
    v_max_f32 v10, v10, v56
    v_sub_f32 v12, v56, v10
    v_mul_f32 v13, s43, v10
    v_mul_f32 v12, s43, v12
    v_fma_f32 v13, v9, s43, -v13
    v_exp_f32 v11, v12
    v_exp_f32 v13, v13
    v_mov_b32 v56, v10
    v_cvt_pk_bf16_f32 v14, v13, 0
    v_lshlrev_b32 v15, 16, v14
    v_mul_f32 v40, v11, v40
    v_mul_f32 v41, v11, v41
    v_mul_f32 v42, v11, v42
    v_mul_f32 v43, v11, v43
    v_mul_f32 v44, v11, v44
    v_mul_f32 v45, v11, v45
    v_mul_f32 v46, v11, v46
    v_mul_f32 v47, v11, v47
    v_fma_f32 v57, v57, v11, v15
    s_waitcnt vmcnt(18)
    v_dot2c_f32_bf16_dpp v40, v14, v176 row_newbcast:0 row_mask:0xf bank_mask:0xf
    v_dot2c_f32_bf16_dpp v41, v15, v176 row_newbcast:0 row_mask:0xf bank_mask:0xf
    v_dot2c_f32_bf16_dpp v42, v14, v177 row_newbcast:0 row_mask:0xf bank_mask:0xf
    v_dot2c_f32_bf16_dpp v43, v15, v177 row_newbcast:0 row_mask:0xf bank_mask:0xf
    v_dot2c_f32_bf16_dpp v44, v14, v178 row_newbcast:0 row_mask:0xf bank_mask:0xf
    v_dot2c_f32_bf16_dpp v45, v15, v178 row_newbcast:0 row_mask:0xf bank_mask:0xf
    v_dot2c_f32_bf16_dpp v46, v14, v179 row_newbcast:0 row_mask:0xf bank_mask:0xf
    v_dot2c_f32_bf16_dpp v47, v15, v179 row_newbcast:0 row_mask:0xf bank_mask:0xf
    v_dot2c_f32_bf16_dpp v40, v14, v180 row_newbcast:8 row_mask:0xf bank_mask:0xf
    v_dot2c_f32_bf16_dpp v41, v15, v180 row_newbcast:8 row_mask:0xf bank_mask:0xf
    v_dot2c_f32_bf16_dpp v42, v14, v181 row_newbcast:8 row_mask:0xf bank_mask:0xf
    v_dot2c_f32_bf16_dpp v43, v15, v181 row_newbcast:8 row_mask:0xf bank_mask:0xf
    v_dot2c_f32_bf16_dpp v44, v14, v182 row_newbcast:8 row_mask:0xf bank_mask:0xf
    v_dot2c_f32_bf16_dpp v45, v15, v182 row_newbcast:8 row_mask:0xf bank_mask:0xf
    v_dot2c_f32_bf16_dpp v46, v14, v183 row_newbcast:8 row_mask:0xf bank_mask:0xf
    v_dot2c_f32_bf16_dpp v47, v15, v183 row_newbcast:8 row_mask:0xf bank_mask:0xf
    v_dot2c_f32_bf16_dpp v40, v14, v184 row_newbcast:4 row_mask:0xf bank_mask:0xf
    v_dot2c_f32_bf16_dpp v41, v15, v184 row_newbcast:4 row_mask:0xf bank_mask:0xf
    v_dot2c_f32_bf16_dpp v42, v14, v185 row_newbcast:4 row_mask:0xf bank_mask:0xf
    v_dot2c_f32_bf16_dpp v43, v15, v185 row_newbcast:4 row_mask:0xf bank_mask:0xf
    v_dot2c_f32_bf16_dpp v44, v14, v186 row_newbcast:4 row_mask:0xf bank_mask:0xf
    v_dot2c_f32_bf16_dpp v45, v15, v186 row_newbcast:4 row_mask:0xf bank_mask:0xf
    v_dot2c_f32_bf16_dpp v46, v14, v187 row_newbcast:4 row_mask:0xf bank_mask:0xf
    v_dot2c_f32_bf16_dpp v47, v15, v187 row_newbcast:4 row_mask:0xf bank_mask:0xf
    v_dot2c_f32_bf16_dpp v40, v14, v188 row_newbcast:12 row_mask:0xf bank_mask:0xf
    v_dot2c_f32_bf16_dpp v41, v15, v188 row_newbcast:12 row_mask:0xf bank_mask:0xf
    v_dot2c_f32_bf16_dpp v42, v14, v189 row_newbcast:12 row_mask:0xf bank_mask:0xf
    v_dot2c_f32_bf16_dpp v43, v15, v189 row_newbcast:12 row_mask:0xf bank_mask:0xf
    v_dot2c_f32_bf16_dpp v44, v14, v190 row_newbcast:12 row_mask:0xf bank_mask:0xf
    v_dot2c_f32_bf16_dpp v45, v15, v190 row_newbcast:12 row_mask:0xf bank_mask:0xf
    v_dot2c_f32_bf16_dpp v46, v14, v191 row_newbcast:12 row_mask:0xf bank_mask:0xf
    v_dot2c_f32_bf16_dpp v47, v15, v191 row_newbcast:12 row_mask:0xf bank_mask:0xf
    buffer_load_dwordx4 v[176:179], v2, s[56:59], s84 offen offset:0 nt
    buffer_load_dwordx4 v[180:183], v2, s[56:59], s84 offen offset:1024 nt
    buffer_load_dwordx4 v[184:187], v2, s[56:59], s84 offen offset:2048 nt
    buffer_load_dwordx4 v[188:191], v2, s[56:59], s84 offen offset:3072 nt
    s_mov_b32 s86, s78
    v_lshrrev_b32 v3, 5, v1
    v_lshrrev_b32 v4, 2, v1
    v_and_b32 v4, 7, v4
    v_lshlrev_b32 v3, 9, v3
    v_add_u32 v3, v3, v4
    s_lshl_b32 s74, s72, 4
    v_add_u32 v3, s74, v3
    v_lshlrev_b32 v5, 4, v3
    v_lshlrev_b32 v6, 10, v3
    v_and_b32 v4, 3, v1
    v_lshl_add_u32 v6, v4, 5, v6
    s_lshl_b32 s74, s73, 7
    s_add_u32 s74, s74, 0x100000
    s_mov_b32 s75, 0x20000
    s_add_u32 s76, s74, 8192
    s_add_u32 s77, s75, 128
    s_waitcnt vmcnt(16)
    v_xor_b32 v24, s42, v225
    v_xor_b32 v25, s42, v227
    v_or_b32 v24, v24, v25
    v_xor_b32 v25, s42, v229
    v_or_b32 v24, v24, v25
    v_xor_b32 v25, s42, v231
    v_or_b32 v24, v24, v25
    v_xor_b32 v25, s42, v233
    v_or_b32 v24, v24, v25
    v_xor_b32 v25, s42, v235
    v_or_b32 v24, v24, v25
    v_xor_b32 v25, s42, v237
    v_or_b32 v24, v24, v25
    v_xor_b32 v25, s42, v239
    v_or_b32 v24, v24, v25
    v_xor_b32 v25, s42, v241
    v_or_b32 v24, v24, v25
    v_xor_b32 v25, s42, v243
    v_or_b32 v24, v24, v25
    v_xor_b32 v25, s42, v245
    v_or_b32 v24, v24, v25
    v_xor_b32 v25, s42, v247
    v_or_b32 v24, v24, v25
    v_cmp_ne_u32 vcc, 0, v24
    s_nop 0
    s_cmp_eq_u64 vcc, 0
    s_cbranch_scc1 L_pc_ok_70
    s_mov_b32 s96, 0
L_pc_poll_71:
    s_nop 2
    buffer_load_dwordx4 v[224:227], v6, s[60:63], s74 offen sc0 sc1
    buffer_load_dwordx4 v[228:231], v6, s[60:63], s74 offen offset:16 sc0 sc1
    buffer_load_dwordx4 v[232:235], v5, s[60:63], s75 offen sc0 sc1
    buffer_load_dwordx4 v[236:239], v6, s[60:63], s76 offen sc0 sc1
    buffer_load_dwordx4 v[240:243], v6, s[60:63], s76 offen offset:16 sc0 sc1
    buffer_load_dwordx4 v[244:247], v5, s[60:63], s77 offen sc0 sc1
    s_waitcnt vmcnt(0)
    s_mov_b64 exec, -1
    v_xor_b32 v24, s42, v225
    v_xor_b32 v25, s42, v227
    v_or_b32 v24, v24, v25
    v_xor_b32 v25, s42, v229
    v_or_b32 v24, v24, v25
    v_xor_b32 v25, s42, v231
    v_or_b32 v24, v24, v25
    v_xor_b32 v25, s42, v233
    v_or_b32 v24, v24, v25
    v_xor_b32 v25, s42, v235
    v_or_b32 v24, v24, v25
    v_xor_b32 v25, s42, v237
    v_or_b32 v24, v24, v25
    v_xor_b32 v25, s42, v239
    v_or_b32 v24, v24, v25
    v_xor_b32 v25, s42, v241
    v_or_b32 v24, v24, v25
    v_xor_b32 v25, s42, v243
    v_or_b32 v24, v24, v25
    v_xor_b32 v25, s42, v245
    v_or_b32 v24, v24, v25
    v_xor_b32 v25, s42, v247
    v_or_b32 v24, v24, v25
    v_cmp_ne_u32 vcc, 0, v24
    s_nop 0
    s_cmp_eq_u64 vcc, 0
    s_cbranch_scc1 L_pc_ok_70
    s_sleep 64
    s_add_u32 s96, s96, 1
    s_cmp_lt_u32 s96, 0x20000
    s_cbranch_scc1 L_pc_poll_71
    s_mov_b64 exec, -1
L_pc_ok_70:
    s_nop 2
    v_max_f32 v3, v232, v244
    s_nop 1
    v_max_f32_dpp v3, v3, v3 row_ror:4 row_mask:0xf bank_mask:0xf
    s_nop 1
    v_max_f32_dpp v3, v3, v3 row_ror:8 row_mask:0xf bank_mask:0xf
    v_mov_b32 v4, v3
    s_nop 1
    v_permlane16_swap_b32 v3, v4
    s_nop 0
    v_max_f32 v3, v3, v4
    v_sub_f32 v4, v232, v3
    v_mul_f32 v4, s43, v4
    v_exp_f32 v4, v4
    v_sub_f32 v5, v244, v3
    v_mul_f32 v5, s43, v5
    v_exp_f32 v5, v5
    s_nop 0
    v_mul_f32 v6, v4, v224
    v_fmac_f32 v6, v5, v236
    v_mul_f32 v7, v4, v226
    v_fmac_f32 v7, v5, v238
    v_mul_f32 v8, v4, v228
    v_fmac_f32 v8, v5, v240
    v_mul_f32 v9, v4, v230
    v_fmac_f32 v9, v5, v242
    v_mul_f32 v10, v4, v234
    v_fmac_f32 v10, v5, v246
    s_nop 0
    v_add_f32_dpp v6, v6, v6 row_ror:4 row_mask:0xf bank_mask:0xf
    v_add_f32_dpp v7, v7, v7 row_ror:4 row_mask:0xf bank_mask:0xf
    v_add_f32_dpp v8, v8, v8 row_ror:4 row_mask:0xf bank_mask:0xf
    v_add_f32_dpp v9, v9, v9 row_ror:4 row_mask:0xf bank_mask:0xf
    v_add_f32_dpp v10, v10, v10 row_ror:4 row_mask:0xf bank_mask:0xf
    v_add_f32_dpp v6, v6, v6 row_ror:8 row_mask:0xf bank_mask:0xf
    v_add_f32_dpp v7, v7, v7 row_ror:8 row_mask:0xf bank_mask:0xf
    v_add_f32_dpp v8, v8, v8 row_ror:8 row_mask:0xf bank_mask:0xf
    v_add_f32_dpp v9, v9, v9 row_ror:8 row_mask:0xf bank_mask:0xf
    v_add_f32_dpp v10, v10, v10 row_ror:8 row_mask:0xf bank_mask:0xf
    v_mov_b32 v11, v6
    v_mov_b32 v12, v7
    v_mov_b32 v13, v8
    v_mov_b32 v14, v9
    v_mov_b32 v15, v10
    s_nop 0
    v_permlane16_swap_b32 v6, v11
    v_permlane16_swap_b32 v7, v12
    v_permlane16_swap_b32 v8, v13
    v_permlane16_swap_b32 v9, v14
    v_permlane16_swap_b32 v10, v15
    s_nop 0
    v_add_f32 v6, v6, v11
    v_add_f32 v7, v7, v12
    v_add_f32 v8, v8, v13
    v_add_f32 v9, v9, v14
    v_add_f32 v10, v10, v15
    v_rcp_f32 v10, v10
    s_nop 0
    v_mul_f32 v6, v10, v6
    v_mul_f32 v7, v10, v7
    v_mul_f32 v8, v10, v8
    v_mul_f32 v9, v10, v9
    v_mov_b32 v24, 17956
    s_mov_b32 s96, 0
L_clrspin_72:
    s_nop 2
    ds_read_b32 v25, v24
    s_waitcnt lgkmcnt(0)
    v_readfirstlane_b32 s4, v25
    s_nop 0
    s_cmp_eq_u32 s4, s42
    s_cbranch_scc1 L_clrok_73
    s_sleep 1
    s_add_u32 s96, s96, 1
    s_cmp_lt_u32 s96, 0x400000
    s_cbranch_scc1 L_clrspin_72
L_clrok_73:
    s_nop 2
    v_mov_b32 v12, v6
    v_mov_b32 v13, s42
    v_mov_b32 v14, v7
    v_mov_b32 v15, s42
    v_mov_b32 v16, v8
    v_mov_b32 v17, s42
    v_mov_b32 v18, v9
    v_mov_b32 v19, s42
    v_lshrrev_b32 v3, 5, v1
    v_lshlrev_b32 v3, 10, v3
    v_and_b32 v4, 3, v1
    v_lshl_add_u32 v3, v4, 5, v3
    s_lshl_b32 s4, s72, 11
    s_lshl_b32 s5, s73, 7
    s_add_u32 s4, s4, s5
    s_add_u32 s4, s4, 0x30000
    v_and_b32 v4, 0x1c, v1
    v_cmp_eq_u32 vcc, 0, v4
    s_nop 0
    s_and_saveexec_b64 s[94:95], vcc
    buffer_store_dwordx4 v[12:15], v3, s[60:63], s4 offen sc0 sc1
    buffer_store_dwordx4 v[16:19], v3, s[60:63], s4 offen offset:16 sc0 sc1
    s_mov_b64 exec, s[94:95]
    s_nop 1
    s_setprio 0
L_nol1_51:
    s_nop 2
    s_mov_b32 s100, 4
    s_branch L_noside_48
L_st4_50:
    s_nop 2
    s_cmp_lg_u32 s100, 4
    s_cbranch_scc1 L_noside_48
    s_cmp_lt_u32 s101, 104
    s_cbranch_scc1 L_noside_48
    v_mov_b32 v25, 17948
    v_mov_b32 v24, 1
    s_mov_b64 s[94:95], exec
    s_mov_b64 exec, 1
    ds_add_rtn_u32 v24, v25, v24
    s_mov_b64 exec, s[94:95]
    s_waitcnt lgkmcnt(0)
    v_readfirstlane_b32 s82, v24
    s_nop 3
    s_cmp_ge_u32 s82, 8
    s_cbranch_scc1 L_noslice_49
    s_setprio 2
    s_mov_b32 s64, s24
    s_and_b32 s65, s25, 0xffff
    s_mov_b32 s66, 0x400000
    s_mov_b32 s67, 0x00020000
    v_and_b32 v3, 3, v1
    v_lshlrev_b32 v3, 12, v3
    v_lshrrev_b32 v4, 2, v1
    v_and_b32 v4, 7, v4
    v_lshl_add_u32 v3, v4, 4, v3
    s_lshl_b32 s4, s72, 17
    s_lshl_b32 s5, s82, 14
    s_add_u32 s4, s4, s5
    s_lshl_b32 s5, s73, 7
    s_add_u32 s4, s4, s5
    buffer_load_dwordx4 v[192:195], v3, s[64:67], s4 offen offset:0 nt
    buffer_load_dwordx4 v[196:199], v3, s[64:67], s4 offen offset:1024 nt
    buffer_load_dwordx4 v[200:203], v3, s[64:67], s4 offen offset:2048 nt
    buffer_load_dwordx4 v[204:207], v3, s[64:67], s4 offen offset:3072 nt
    v_lshrrev_b32 v3, 5, v1
    v_lshrrev_b32 v4, 2, v1
    v_and_b32 v4, 7, v4
    v_lshlrev_b32 v3, 9, v3
    v_add_u32 v3, v3, v4
    s_lshl_b32 s74, s72, 4
    v_add_u32 v3, s74, v3
    v_lshlrev_b32 v5, 4, v3
    v_lshlrev_b32 v6, 10, v3
    v_and_b32 v4, 3, v1
    v_lshl_add_u32 v6, v4, 5, v6
    s_lshl_b32 s74, s82, 7
    s_add_u32 s74, s74, 0x100000
    s_mov_b32 s75, 0x20000
    s_add_u32 s76, s74, 8192
    s_add_u32 s77, s75, 128
    v_lshrrev_b32 v6, 5, v1
    v_lshlrev_b32 v6, 10, v6
    v_and_b32 v4, 3, v1
    v_lshl_add_u32 v6, v4, 5, v6
    s_lshl_b32 s74, s72, 11
    s_lshl_b32 s75, s82, 7
    s_add_u32 s74, s74, s75
    s_add_u32 s74, s74, 0x30000
    buffer_load_dwordx4 v[224:227], v6, s[60:63], s74 offen sc0 sc1
    buffer_load_dwordx4 v[228:231], v6, s[60:63], s74 offen offset:16 sc0 sc1
    s_add_u32 s100, s82, 16
    v_mov_b32 v25, 17920
    v_mov_b32 v24, 1
    s_mov_b64 s[94:95], exec
    s_mov_b64 exec, 1
    ds_add_rtn_u32 v26, v25, v24
    s_mov_b64 exec, s[94:95]
    s_cmp_eq_u32 s85, s87
    s_cbranch_scc1 L_noswap_74
    v_swap_b32 v32, v36
    v_swap_b32 v33, v37
    v_swap_b32 v34, v38
    v_swap_b32 v35, v39
    v_swap_b32 v40, v48
    v_swap_b32 v41, v49
    v_swap_b32 v42, v50
    v_swap_b32 v43, v51
    v_swap_b32 v44, v52
    v_swap_b32 v45, v53
    v_swap_b32 v46, v54
    v_swap_b32 v47, v55
    v_swap_b32 v56, v58
    v_swap_b32 v57, v59
    s_mov_b32 s87, s85
    s_mov_b32 s99, 1
L_noswap_74:
    s_nop 2
    s_waitcnt vmcnt(18)
    v_dot2_f32_bf16 v3, v128, v32, 0
    v_dot2_f32_bf16 v4, v132, v32, 0
    v_dot2_f32_bf16 v5, v136, v32, 0
    v_dot2_f32_bf16 v6, v140, v32, 0
    v_dot2_f32_bf16 v3, v129, v33, v3
    v_dot2_f32_bf16 v4, v133, v33, v4
    v_dot2_f32_bf16 v5, v137, v33, v5
    v_dot2_f32_bf16 v6, v141, v33, v6
    v_dot2_f32_bf16 v3, v130, v34, v3
    v_dot2_f32_bf16 v4, v134, v34, v4
    v_dot2_f32_bf16 v5, v138, v34, v5
    v_dot2_f32_bf16 v6, v142, v34, v6
    v_dot2_f32_bf16 v3, v131, v35, v3
    v_dot2_f32_bf16 v4, v135, v35, v4
    v_dot2_f32_bf16 v5, v139, v35, v5
    v_dot2_f32_bf16 v6, v143, v35, v6
    s_waitcnt lgkmcnt(0)
    v_readfirstlane_b32 s74, v26
    s_nop 3
    s_mov_b32 s101, s74
    s_lshr_b32 s75, s74, 3
    s_and_b32 s76, s74, 7
    s_cmp_lt_u32 s74, 192
    s_cbranch_scc1 L_stat_76
    s_sub_u32 s74, s74, 192
    s_lshr_b32 s75, s74, 3
    s_and_b32 s76, s74, 7
    s_min_u32 s75, s75, 300
    s_cmp_lg_u32 s76, 0
    s_cbranch_scc1 L_norq_75
    s_add_u32 s89, s75, 1
    s_mov_b32 s90, 1
    s_mov_b32 s91, 0
    s_atomic_add_x2 s[90:91], s[92:93], 0 glc
    s_cmp_eq_u32 s89, 0
    s_cbranch_scc1 L_noreq_78
    s_waitcnt lgkmcnt(0)
    s_mov_b32 s96, 0
L_rqretry_79:
    s_nop 2
    s_cmp_eq_u32 s91, s42
    s_cbranch_scc1 L_rqok_80
    s_sleep 8
    s_mov_b32 s90, 1
    s_mov_b32 s91, 0
    s_atomic_add_x2 s[90:91], s[92:93], 0 glc
    s_waitcnt lgkmcnt(0)
    s_add_u32 s96, s96, 1
    s_cmp_lt_u32 s96, 0x20000
    s_cbranch_scc1 L_rqretry_79
L_rqok_80:
    s_nop 2
    s_sub_u32 s4, s89, 1
    s_lshl_b32 s4, s4, 2
    v_mov_b32 v24, s4
    v_mov_b32 v25, s90
    ds_write_b32 v24, v25 offset:19392
    s_mov_b32 s89, 0
L_noreq_78:
    s_nop 2
L_norq_75:
    s_nop 2
    s_lshl_b32 s4, s75, 2
    v_mov_b32 v24, s4
    s_mov_b32 s96, 0
L_dspin_81:
    s_nop 2
    ds_read_b32 v25, v24 offset:19392
    s_waitcnt lgkmcnt(0)
    v_readfirstlane_b32 s77, v25
    s_nop 3
    s_add_u32 s96, s96, 1
    s_cmp_ge_u32 s96, 0x400000
    s_cbranch_scc1 L_dgot_82
    s_cmp_eq_u32 s77, -1
    s_cbranch_scc1 L_dspin_81
L_dgot_82:
    s_nop 2
    s_min_u32 s77, s77, 4096
    s_add_u32 s77, s77, 192
    s_branch L_gotg_77
L_stat_76:
    s_nop 2
    s_lshl_b32 s77, s75, 3
    s_add_u32 s77, s77, s73
L_gotg_77:
    s_nop 2
    s_cmp_ge_u32 s77, 256
    s_cbranch_scc1 L_drain0
    s_and_b32 s4, s77, 7
    s_lshr_b32 s78, s4, 2
    s_lshl_b32 s5, s78, 5
    s_add_u32 s5, s5, s72
    s_lshl_b32 s5, s5, 22
    s_and_b32 s4, s4, 3
    s_lshl_b32 s4, s4, 20
    s_add_u32 s5, s5, s4
    s_lshr_b32 s4, s77, 3
    s_lshl_b32 s4, s4, 15
    s_add_u32 s5, s5, s4
    s_lshl_b32 s4, s76, 12
    s_add_u32 s83, s5, s4
    buffer_load_dwordx4 v[128:131], v2, s[52:55], s83 offen offset:0 nt
    buffer_load_dwordx4 v[132:135], v2, s[52:55], s83 offen offset:1024 nt
    buffer_load_dwordx4 v[136:139], v2, s[52:55], s83 offen offset:2048 nt
    buffer_load_dwordx4 v[140:143], v2, s[52:55], s83 offen offset:3072 nt
    v_add_f32_dpp v7, v3, v3 row_ror:8 row_mask:0xf bank_mask:0x3
    v_add_f32_dpp v7, v4, v4 row_ror:8 row_mask:0xf bank_mask:0xc
    v_add_f32_dpp v8, v5, v5 row_ror:8 row_mask:0xf bank_mask:0x3
    v_add_f32_dpp v8, v6, v6 row_ror:8 row_mask:0xf bank_mask:0xc
    v_add_f32_dpp v9, v7, v7 row_half_mirror row_mask:0xf bank_mask:0x5
    s_nop 0
    v_add_f32_dpp v9, v8, v8 row_half_mirror row_mask:0xf bank_mask:0xa
    s_nop 1
    v_add_f32_dpp v9, v9, v9 quad_perm:[1,0,3,2] row_mask:0xf bank_mask:0xf
    s_nop 1
    v_add_f32_dpp v9, v9, v9 quad_perm:[2,3,0,1] row_mask:0xf bank_mask:0xf
    s_nop 1
    v_max_f32_dpp v10, v9, v9 row_half_mirror row_mask:0xf bank_mask:0xf
    s_nop 1
    v_max_f32_dpp v10, v10, v10 row_ror:8 row_mask:0xf bank_mask:0xf
    v_max_f32 v10, v10, v56
    v_sub_f32 v12, v56, v10
    v_mul_f32 v13, s43, v10
    v_mul_f32 v12, s43, v12
    v_fma_f32 v13, v9, s43, -v13
    v_exp_f32 v11, v12
    v_exp_f32 v13, v13
    v_mov_b32 v56, v10
    v_cvt_pk_bf16_f32 v14, v13, 0
    v_lshlrev_b32 v15, 16, v14
    v_mul_f32 v40, v11, v40
    v_mul_f32 v41, v11, v41
    v_mul_f32 v42, v11, v42
    v_mul_f32 v43, v11, v43
    v_mul_f32 v44, v11, v44
    v_mul_f32 v45, v11, v45
    v_mul_f32 v46, v11, v46
    v_mul_f32 v47, v11, v47
    v_fma_f32 v57, v57, v11, v15
    s_waitcnt vmcnt(18)
    v_dot2c_f32_bf16_dpp v40, v14, v144 row_newbcast:0 row_mask:0xf bank_mask:0xf
    v_dot2c_f32_bf16_dpp v41, v15, v144 row_newbcast:0 row_mask:0xf bank_mask:0xf
    v_dot2c_f32_bf16_dpp v42, v14, v145 row_newbcast:0 row_mask:0xf bank_mask:0xf
    v_dot2c_f32_bf16_dpp v43, v15, v145 row_newbcast:0 row_mask:0xf bank_mask:0xf
    v_dot2c_f32_bf16_dpp v44, v14, v146 row_newbcast:0 row_mask:0xf bank_mask:0xf
    v_dot2c_f32_bf16_dpp v45, v15, v146 row_newbcast:0 row_mask:0xf bank_mask:0xf
    v_dot2c_f32_bf16_dpp v46, v14, v147 row_newbcast:0 row_mask:0xf bank_mask:0xf
    v_dot2c_f32_bf16_dpp v47, v15, v147 row_newbcast:0 row_mask:0xf bank_mask:0xf
    v_dot2c_f32_bf16_dpp v40, v14, v148 row_newbcast:8 row_mask:0xf bank_mask:0xf
    v_dot2c_f32_bf16_dpp v41, v15, v148 row_newbcast:8 row_mask:0xf bank_mask:0xf
    v_dot2c_f32_bf16_dpp v42, v14, v149 row_newbcast:8 row_mask:0xf bank_mask:0xf
    v_dot2c_f32_bf16_dpp v43, v15, v149 row_newbcast:8 row_mask:0xf bank_mask:0xf
    v_dot2c_f32_bf16_dpp v44, v14, v150 row_newbcast:8 row_mask:0xf bank_mask:0xf
    v_dot2c_f32_bf16_dpp v45, v15, v150 row_newbcast:8 row_mask:0xf bank_mask:0xf
    v_dot2c_f32_bf16_dpp v46, v14, v151 row_newbcast:8 row_mask:0xf bank_mask:0xf
    v_dot2c_f32_bf16_dpp v47, v15, v151 row_newbcast:8 row_mask:0xf bank_mask:0xf
    v_dot2c_f32_bf16_dpp v40, v14, v152 row_newbcast:4 row_mask:0xf bank_mask:0xf
    v_dot2c_f32_bf16_dpp v41, v15, v152 row_newbcast:4 row_mask:0xf bank_mask:0xf
    v_dot2c_f32_bf16_dpp v42, v14, v153 row_newbcast:4 row_mask:0xf bank_mask:0xf
    v_dot2c_f32_bf16_dpp v43, v15, v153 row_newbcast:4 row_mask:0xf bank_mask:0xf
    v_dot2c_f32_bf16_dpp v44, v14, v154 row_newbcast:4 row_mask:0xf bank_mask:0xf
    v_dot2c_f32_bf16_dpp v45, v15, v154 row_newbcast:4 row_mask:0xf bank_mask:0xf
    v_dot2c_f32_bf16_dpp v46, v14, v155 row_newbcast:4 row_mask:0xf bank_mask:0xf
    v_dot2c_f32_bf16_dpp v47, v15, v155 row_newbcast:4 row_mask:0xf bank_mask:0xf
    v_dot2c_f32_bf16_dpp v40, v14, v156 row_newbcast:12 row_mask:0xf bank_mask:0xf
    v_dot2c_f32_bf16_dpp v41, v15, v156 row_newbcast:12 row_mask:0xf bank_mask:0xf
    v_dot2c_f32_bf16_dpp v42, v14, v157 row_newbcast:12 row_mask:0xf bank_mask:0xf
    v_dot2c_f32_bf16_dpp v43, v15, v157 row_newbcast:12 row_mask:0xf bank_mask:0xf
    v_dot2c_f32_bf16_dpp v44, v14, v158 row_newbcast:12 row_mask:0xf bank_mask:0xf
    v_dot2c_f32_bf16_dpp v45, v15, v158 row_newbcast:12 row_mask:0xf bank_mask:0xf
    v_dot2c_f32_bf16_dpp v46, v14, v159 row_newbcast:12 row_mask:0xf bank_mask:0xf
    v_dot2c_f32_bf16_dpp v47, v15, v159 row_newbcast:12 row_mask:0xf bank_mask:0xf
    buffer_load_dwordx4 v[144:147], v2, s[56:59], s83 offen offset:0 nt
    buffer_load_dwordx4 v[148:151], v2, s[56:59], s83 offen offset:1024 nt
    buffer_load_dwordx4 v[152:155], v2, s[56:59], s83 offen offset:2048 nt
    buffer_load_dwordx4 v[156:159], v2, s[56:59], s83 offen offset:3072 nt
    s_mov_b32 s85, s78
    v_mov_b32 v25, 17920
    v_mov_b32 v24, 1
    s_mov_b64 s[94:95], exec
    s_mov_b64 exec, 1
    ds_add_rtn_u32 v26, v25, v24
    s_mov_b64 exec, s[94:95]
    s_cmp_eq_u32 s86, s87
    s_cbranch_scc1 L_noswap_83
    v_swap_b32 v32, v36
    v_swap_b32 v33, v37
    v_swap_b32 v34, v38
    v_swap_b32 v35, v39
    v_swap_b32 v40, v48
    v_swap_b32 v41, v49
    v_swap_b32 v42, v50
    v_swap_b32 v43, v51
    v_swap_b32 v44, v52
    v_swap_b32 v45, v53
    v_swap_b32 v46, v54
    v_swap_b32 v47, v55
    v_swap_b32 v56, v58
    v_swap_b32 v57, v59
    s_mov_b32 s87, s86
    s_mov_b32 s99, 1
L_noswap_83:
    s_nop 2
    s_waitcnt vmcnt(18)
    v_dot2_f32_bf16 v3, v160, v32, 0
    v_dot2_f32_bf16 v4, v164, v32, 0
    v_dot2_f32_bf16 v5, v168, v32, 0
    v_dot2_f32_bf16 v6, v172, v32, 0
    v_dot2_f32_bf16 v3, v161, v33, v3
    v_dot2_f32_bf16 v4, v165, v33, v4
    v_dot2_f32_bf16 v5, v169, v33, v5
    v_dot2_f32_bf16 v6, v173, v33, v6
    v_dot2_f32_bf16 v3, v162, v34, v3
    v_dot2_f32_bf16 v4, v166, v34, v4
    v_dot2_f32_bf16 v5, v170, v34, v5
    v_dot2_f32_bf16 v6, v174, v34, v6
    v_dot2_f32_bf16 v3, v163, v35, v3
    v_dot2_f32_bf16 v4, v167, v35, v4
    v_dot2_f32_bf16 v5, v171, v35, v5
    v_dot2_f32_bf16 v6, v175, v35, v6
    s_waitcnt lgkmcnt(0)
    v_readfirstlane_b32 s74, v26
    s_nop 3
    s_mov_b32 s101, s74
    s_lshr_b32 s75, s74, 3
    s_and_b32 s76, s74, 7
    s_cmp_lt_u32 s74, 192
    s_cbranch_scc1 L_stat_85
    s_sub_u32 s74, s74, 192
    s_lshr_b32 s75, s74, 3
    s_and_b32 s76, s74, 7
    s_min_u32 s75, s75, 300
    s_cmp_lg_u32 s76, 0
    s_cbranch_scc1 L_norq_84
    s_add_u32 s89, s75, 1
    s_mov_b32 s90, 1
    s_mov_b32 s91, 0
    s_atomic_add_x2 s[90:91], s[92:93], 0 glc
    s_cmp_eq_u32 s89, 0
    s_cbranch_scc1 L_noreq_87
    s_waitcnt lgkmcnt(0)
    s_mov_b32 s96, 0
L_rqretry_88:
    s_nop 2
    s_cmp_eq_u32 s91, s42
    s_cbranch_scc1 L_rqok_89
    s_sleep 8
    s_mov_b32 s90, 1
    s_mov_b32 s91, 0
    s_atomic_add_x2 s[90:91], s[92:93], 0 glc
    s_waitcnt lgkmcnt(0)
    s_add_u32 s96, s96, 1
    s_cmp_lt_u32 s96, 0x20000
    s_cbranch_scc1 L_rqretry_88
L_rqok_89:
    s_nop 2
    s_sub_u32 s4, s89, 1
    s_lshl_b32 s4, s4, 2
    v_mov_b32 v24, s4
    v_mov_b32 v25, s90
    ds_write_b32 v24, v25 offset:19392
    s_mov_b32 s89, 0
L_noreq_87:
    s_nop 2
L_norq_84:
    s_nop 2
    s_lshl_b32 s4, s75, 2
    v_mov_b32 v24, s4
    s_mov_b32 s96, 0
L_dspin_90:
    s_nop 2
    ds_read_b32 v25, v24 offset:19392
    s_waitcnt lgkmcnt(0)
    v_readfirstlane_b32 s77, v25
    s_nop 3
    s_add_u32 s96, s96, 1
    s_cmp_ge_u32 s96, 0x400000
    s_cbranch_scc1 L_dgot_91
    s_cmp_eq_u32 s77, -1
    s_cbranch_scc1 L_dspin_90
L_dgot_91:
    s_nop 2
    s_min_u32 s77, s77, 4096
    s_add_u32 s77, s77, 192
    s_branch L_gotg_86
L_stat_85:
    s_nop 2
    s_lshl_b32 s77, s75, 3
    s_add_u32 s77, s77, s73
L_gotg_86:
    s_nop 2
    s_cmp_ge_u32 s77, 256
    s_cbranch_scc1 L_drain1
    s_and_b32 s4, s77, 7
    s_lshr_b32 s78, s4, 2
    s_lshl_b32 s5, s78, 5
    s_add_u32 s5, s5, s72
    s_lshl_b32 s5, s5, 22
    s_and_b32 s4, s4, 3
    s_lshl_b32 s4, s4, 20
    s_add_u32 s5, s5, s4
    s_lshr_b32 s4, s77, 3
    s_lshl_b32 s4, s4, 15
    s_add_u32 s5, s5, s4
    s_lshl_b32 s4, s76, 12
    s_add_u32 s84, s5, s4
    buffer_load_dwordx4 v[160:163], v2, s[52:55], s84 offen offset:0 nt
    buffer_load_dwordx4 v[164:167], v2, s[52:55], s84 offen offset:1024 nt
    buffer_load_dwordx4 v[168:171], v2, s[52:55], s84 offen offset:2048 nt
    buffer_load_dwordx4 v[172:175], v2, s[52:55], s84 offen offset:3072 nt
    v_add_f32_dpp v7, v3, v3 row_ror:8 row_mask:0xf bank_mask:0x3
    v_add_f32_dpp v7, v4, v4 row_ror:8 row_mask:0xf bank_mask:0xc
    v_add_f32_dpp v8, v5, v5 row_ror:8 row_mask:0xf bank_mask:0x3
    v_add_f32_dpp v8, v6, v6 row_ror:8 row_mask:0xf bank_mask:0xc
    v_add_f32_dpp v9, v7, v7 row_half_mirror row_mask:0xf bank_mask:0x5
    s_nop 0
    v_add_f32_dpp v9, v8, v8 row_half_mirror row_mask:0xf bank_mask:0xa
    s_nop 1
    v_add_f32_dpp v9, v9, v9 quad_perm:[1,0,3,2] row_mask:0xf bank_mask:0xf
    s_nop 1
    v_add_f32_dpp v9, v9, v9 quad_perm:[2,3,0,1] row_mask:0xf bank_mask:0xf
    s_nop 1
    v_max_f32_dpp v10, v9, v9 row_half_mirror row_mask:0xf bank_mask:0xf
    s_nop 1
    v_max_f32_dpp v10, v10, v10 row_ror:8 row_mask:0xf bank_mask:0xf
    v_max_f32 v10, v10, v56
    v_sub_f32 v12, v56, v10
    v_mul_f32 v13, s43, v10
    v_mul_f32 v12, s43, v12
    v_fma_f32 v13, v9, s43, -v13
    v_exp_f32 v11, v12
    v_exp_f32 v13, v13
    v_mov_b32 v56, v10
    v_cvt_pk_bf16_f32 v14, v13, 0
    v_lshlrev_b32 v15, 16, v14
    v_mul_f32 v40, v11, v40
    v_mul_f32 v41, v11, v41
    v_mul_f32 v42, v11, v42
    v_mul_f32 v43, v11, v43
    v_mul_f32 v44, v11, v44
    v_mul_f32 v45, v11, v45
    v_mul_f32 v46, v11, v46
    v_mul_f32 v47, v11, v47
    v_fma_f32 v57, v57, v11, v15
    s_waitcnt vmcnt(18)
    v_dot2c_f32_bf16_dpp v40, v14, v176 row_newbcast:0 row_mask:0xf bank_mask:0xf
    v_dot2c_f32_bf16_dpp v41, v15, v176 row_newbcast:0 row_mask:0xf bank_mask:0xf
    v_dot2c_f32_bf16_dpp v42, v14, v177 row_newbcast:0 row_mask:0xf bank_mask:0xf
    v_dot2c_f32_bf16_dpp v43, v15, v177 row_newbcast:0 row_mask:0xf bank_mask:0xf
    v_dot2c_f32_bf16_dpp v44, v14, v178 row_newbcast:0 row_mask:0xf bank_mask:0xf
    v_dot2c_f32_bf16_dpp v45, v15, v178 row_newbcast:0 row_mask:0xf bank_mask:0xf
    v_dot2c_f32_bf16_dpp v46, v14, v179 row_newbcast:0 row_mask:0xf bank_mask:0xf
    v_dot2c_f32_bf16_dpp v47, v15, v179 row_newbcast:0 row_mask:0xf bank_mask:0xf
    v_dot2c_f32_bf16_dpp v40, v14, v180 row_newbcast:8 row_mask:0xf bank_mask:0xf
    v_dot2c_f32_bf16_dpp v41, v15, v180 row_newbcast:8 row_mask:0xf bank_mask:0xf
    v_dot2c_f32_bf16_dpp v42, v14, v181 row_newbcast:8 row_mask:0xf bank_mask:0xf
    v_dot2c_f32_bf16_dpp v43, v15, v181 row_newbcast:8 row_mask:0xf bank_mask:0xf
    v_dot2c_f32_bf16_dpp v44, v14, v182 row_newbcast:8 row_mask:0xf bank_mask:0xf
    v_dot2c_f32_bf16_dpp v45, v15, v182 row_newbcast:8 row_mask:0xf bank_mask:0xf
    v_dot2c_f32_bf16_dpp v46, v14, v183 row_newbcast:8 row_mask:0xf bank_mask:0xf
    v_dot2c_f32_bf16_dpp v47, v15, v183 row_newbcast:8 row_mask:0xf bank_mask:0xf
    v_dot2c_f32_bf16_dpp v40, v14, v184 row_newbcast:4 row_mask:0xf bank_mask:0xf
    v_dot2c_f32_bf16_dpp v41, v15, v184 row_newbcast:4 row_mask:0xf bank_mask:0xf
    v_dot2c_f32_bf16_dpp v42, v14, v185 row_newbcast:4 row_mask:0xf bank_mask:0xf
    v_dot2c_f32_bf16_dpp v43, v15, v185 row_newbcast:4 row_mask:0xf bank_mask:0xf
    v_dot2c_f32_bf16_dpp v44, v14, v186 row_newbcast:4 row_mask:0xf bank_mask:0xf
    v_dot2c_f32_bf16_dpp v45, v15, v186 row_newbcast:4 row_mask:0xf bank_mask:0xf
    v_dot2c_f32_bf16_dpp v46, v14, v187 row_newbcast:4 row_mask:0xf bank_mask:0xf
    v_dot2c_f32_bf16_dpp v47, v15, v187 row_newbcast:4 row_mask:0xf bank_mask:0xf
    v_dot2c_f32_bf16_dpp v40, v14, v188 row_newbcast:12 row_mask:0xf bank_mask:0xf
    v_dot2c_f32_bf16_dpp v41, v15, v188 row_newbcast:12 row_mask:0xf bank_mask:0xf
    v_dot2c_f32_bf16_dpp v42, v14, v189 row_newbcast:12 row_mask:0xf bank_mask:0xf
    v_dot2c_f32_bf16_dpp v43, v15, v189 row_newbcast:12 row_mask:0xf bank_mask:0xf
    v_dot2c_f32_bf16_dpp v44, v14, v190 row_newbcast:12 row_mask:0xf bank_mask:0xf
    v_dot2c_f32_bf16_dpp v45, v15, v190 row_newbcast:12 row_mask:0xf bank_mask:0xf
    v_dot2c_f32_bf16_dpp v46, v14, v191 row_newbcast:12 row_mask:0xf bank_mask:0xf
    v_dot2c_f32_bf16_dpp v47, v15, v191 row_newbcast:12 row_mask:0xf bank_mask:0xf
    buffer_load_dwordx4 v[176:179], v2, s[56:59], s84 offen offset:0 nt
    buffer_load_dwordx4 v[180:183], v2, s[56:59], s84 offen offset:1024 nt
    buffer_load_dwordx4 v[184:187], v2, s[56:59], s84 offen offset:2048 nt
    buffer_load_dwordx4 v[188:191], v2, s[56:59], s84 offen offset:3072 nt
    s_mov_b32 s86, s78
    v_lshrrev_b32 v3, 5, v1
    v_lshrrev_b32 v4, 2, v1
    v_and_b32 v4, 7, v4
    v_lshlrev_b32 v3, 9, v3
    v_add_u32 v3, v3, v4
    s_lshl_b32 s74, s72, 4
    v_add_u32 v3, s74, v3
    v_lshlrev_b32 v5, 4, v3
    v_lshlrev_b32 v6, 10, v3
    v_and_b32 v4, 3, v1
    v_lshl_add_u32 v6, v4, 5, v6
    s_lshl_b32 s74, s82, 7
    s_add_u32 s74, s74, 0x100000
    s_mov_b32 s75, 0x20000
    s_add_u32 s76, s74, 8192
    s_add_u32 s77, s75, 128
    v_lshrrev_b32 v6, 5, v1
    v_lshlrev_b32 v6, 10, v6
    v_and_b32 v4, 3, v1
    v_lshl_add_u32 v6, v4, 5, v6
    s_lshl_b32 s74, s72, 11
    s_lshl_b32 s75, s82, 7
    s_add_u32 s74, s74, s75
    s_add_u32 s74, s74, 0x30000
    s_waitcnt vmcnt(16)
    v_xor_b32 v24, s42, v225
    v_xor_b32 v25, s42, v227
    v_or_b32 v24, v24, v25
    v_xor_b32 v25, s42, v229
    v_or_b32 v24, v24, v25
    v_xor_b32 v25, s42, v231
    v_or_b32 v24, v24, v25
    v_cmp_ne_u32 vcc, 0, v24
    s_nop 0
    s_cmp_eq_u64 vcc, 0
    s_cbranch_scc1 L_pc_ok_92
    s_mov_b32 s96, 0
L_pc_poll_93:
    s_nop 2
    buffer_load_dwordx4 v[224:227], v6, s[60:63], s74 offen sc0 sc1
    buffer_load_dwordx4 v[228:231], v6, s[60:63], s74 offen offset:16 sc0 sc1
    s_waitcnt vmcnt(0)
    s_mov_b64 exec, -1
    v_xor_b32 v24, s42, v225
    v_xor_b32 v25, s42, v227
    v_or_b32 v24, v24, v25
    v_xor_b32 v25, s42, v229
    v_or_b32 v24, v24, v25
    v_xor_b32 v25, s42, v231
    v_or_b32 v24, v24, v25
    v_cmp_ne_u32 vcc, 0, v24
    s_nop 0
    s_cmp_eq_u64 vcc, 0
    s_cbranch_scc1 L_pc_ok_92
    s_sleep 64
    s_add_u32 s96, s96, 1
    s_cmp_lt_u32 s96, 0x20000
    s_cbranch_scc1 L_pc_poll_93
    s_mov_b64 exec, -1
L_pc_ok_92:
    s_nop 2
    v_mov_b32 v6, v224
    v_mov_b32 v7, v226
    v_mov_b32 v8, v228
    v_mov_b32 v9, v230
    v_cvt_pk_bf16_f32 v16, v6, 0
    v_lshlrev_b32 v17, 16, v16
    v_cvt_pk_bf16_f32 v18, v7, 0
    v_lshlrev_b32 v19, 16, v18
    v_cvt_pk_bf16_f32 v20, v8, 0
    v_lshlrev_b32 v21, 16, v20
    v_cvt_pk_bf16_f32 v22, v9, 0
    v_lshlrev_b32 v23, 16, v22
    v_mov_b32 v6, 0
    v_mov_b32 v7, 0
    v_mov_b32 v8, 0
    v_mov_b32 v9, 0
    v_mov_b32 v10, 0
    v_mov_b32 v11, 0
    v_mov_b32 v12, 0
    v_mov_b32 v13, 0
    v_dot2c_f32_bf16 v6, v16, v192
    v_dot2c_f32_bf16 v7, v17, v192
    v_dot2c_f32_bf16 v8, v16, v193
    v_dot2c_f32_bf16 v9, v17, v193
    v_dot2c_f32_bf16 v10, v16, v194
    v_dot2c_f32_bf16 v11, v17, v194
    v_dot2c_f32_bf16 v12, v16, v195
    v_dot2c_f32_bf16 v13, v17, v195
    v_dot2c_f32_bf16 v6, v18, v196
    v_dot2c_f32_bf16 v7, v19, v196
    v_dot2c_f32_bf16 v8, v18, v197
    v_dot2c_f32_bf16 v9, v19, v197
    v_dot2c_f32_bf16 v10, v18, v198
    v_dot2c_f32_bf16 v11, v19, v198
    v_dot2c_f32_bf16 v12, v18, v199
    v_dot2c_f32_bf16 v13, v19, v199
    v_dot2c_f32_bf16 v6, v20, v200
    v_dot2c_f32_bf16 v7, v21, v200
    v_dot2c_f32_bf16 v8, v20, v201
    v_dot2c_f32_bf16 v9, v21, v201
    v_dot2c_f32_bf16 v10, v20, v202
    v_dot2c_f32_bf16 v11, v21, v202
    v_dot2c_f32_bf16 v12, v20, v203
    v_dot2c_f32_bf16 v13, v21, v203
    v_dot2c_f32_bf16 v6, v22, v204
    v_dot2c_f32_bf16 v7, v23, v204
    v_dot2c_f32_bf16 v8, v22, v205
    v_dot2c_f32_bf16 v9, v23, v205
    v_dot2c_f32_bf16 v10, v22, v206
    v_dot2c_f32_bf16 v11, v23, v206
    v_dot2c_f32_bf16 v12, v22, v207
    v_dot2c_f32_bf16 v13, v23, v207
    v_add_f32_dpp v6, v6, v6 quad_perm:[1,0,3,2] row_mask:0xf bank_mask:0xf
    v_add_f32_dpp v7, v7, v7 quad_perm:[1,0,3,2] row_mask:0xf bank_mask:0xf
    v_add_f32_dpp v8, v8, v8 quad_perm:[1,0,3,2] row_mask:0xf bank_mask:0xf
    v_add_f32_dpp v9, v9, v9 quad_perm:[1,0,3,2] row_mask:0xf bank_mask:0xf
    v_add_f32_dpp v10, v10, v10 quad_perm:[1,0,3,2] row_mask:0xf bank_mask:0xf
    v_add_f32_dpp v11, v11, v11 quad_perm:[1,0,3,2] row_mask:0xf bank_mask:0xf
    v_add_f32_dpp v12, v12, v12 quad_perm:[1,0,3,2] row_mask:0xf bank_mask:0xf
    v_add_f32_dpp v13, v13, v13 quad_perm:[1,0,3,2] row_mask:0xf bank_mask:0xf
    v_add_f32_dpp v6, v6, v6 quad_perm:[2,3,0,1] row_mask:0xf bank_mask:0xf
    v_add_f32_dpp v7, v7, v7 quad_perm:[2,3,0,1] row_mask:0xf bank_mask:0xf
    v_add_f32_dpp v8, v8, v8 quad_perm:[2,3,0,1] row_mask:0xf bank_mask:0xf
    v_add_f32_dpp v9, v9, v9 quad_perm:[2,3,0,1] row_mask:0xf bank_mask:0xf
    v_add_f32_dpp v10, v10, v10 quad_perm:[2,3,0,1] row_mask:0xf bank_mask:0xf
    v_add_f32_dpp v11, v11, v11 quad_perm:[2,3,0,1] row_mask:0xf bank_mask:0xf
    v_add_f32_dpp v12, v12, v12 quad_perm:[2,3,0,1] row_mask:0xf bank_mask:0xf
    v_add_f32_dpp v13, v13, v13 quad_perm:[2,3,0,1] row_mask:0xf bank_mask:0xf
    v_lshrrev_b32 v3, 5, v1
    v_lshlrev_b32 v3, 8, v3
    v_lshrrev_b32 v4, 2, v1
    v_and_b32 v4, 7, v4
    v_lshl_add_u32 v3, v4, 5, v3
    s_lshl_b32 s4, s82, 9
    v_add_u32 v3, s4, v3
    v_and_b32 v4, 3, v1
    v_cmp_eq_u32 vcc, 0, v4
    s_nop 0
    s_and_saveexec_b64 s[94:95], vcc
    ds_write_b128 v3, v[6:9] offset:28864
    ds_write_b128 v3, v[10:13] offset:28880
    s_mov_b64 exec, s[94:95]
    s_waitcnt lgkmcnt(0)
    v_mov_b32 v12, 17932
    v_mov_b32 v13, 1
    s_mov_b64 s[94:95], exec
    s_mov_b64 exec, 1
    ds_add_rtn_u32 v12, v12, v13
    s_mov_b64 exec, s[94:95]
    s_waitcnt lgkmcnt(0)
    v_readfirstlane_b32 s4, v12
    s_nop 3
    s_cmp_lg_u32 s4, 7
    s_cbranch_scc1 L_pc_skip_94
    v_mov_b32 v24, 17956
    s_mov_b32 s96, 0
L_clrspin_95:
    s_nop 2
    ds_read_b32 v25, v24
    s_waitcnt lgkmcnt(0)
    v_readfirstlane_b32 s4, v25
    s_nop 0
    s_cmp_eq_u32 s4, s42
    s_cbranch_scc1 L_clrok_96
    s_sleep 1
    s_add_u32 s96, s96, 1
    s_cmp_lt_u32 s96, 0x400000
    s_cbranch_scc1 L_clrspin_95
L_clrok_96:
    s_nop 2
    v_lshlrev_b32 v3, 3, v1
    ds_read_b64 v[10:11], v3 offset:28864
    ds_read_b64 v[12:13], v3 offset:29376
    ds_read_b64 v[14:15], v3 offset:29888
    ds_read_b64 v[16:17], v3 offset:30400
    ds_read_b64 v[18:19], v3 offset:30912
    ds_read_b64 v[20:21], v3 offset:31424
    ds_read_b64 v[22:23], v3 offset:31936
    ds_read_b64 v[24:25], v3 offset:32448
    v_lshrrev_b32 v8, 5, v1
    v_lshlrev_b32 v8, 12, v8
    v_and_b32 v9, 31, v1
    v_lshl_add_u32 v8, v9, 4, v8
    s_lshl_b32 s4, s72, 13
    s_lshl_b32 s5, s73, 9
    s_add_u32 s4, s4, s5
    s_add_u32 s4, s4, 0x300000
    s_waitcnt lgkmcnt(0)
    v_add_f32 v10, v10, v12
    v_add_f32 v11, v11, v13
    v_add_f32 v14, v14, v16
    v_add_f32 v15, v15, v17
    v_add_f32 v18, v18, v20
    v_add_f32 v19, v19, v21
    v_add_f32 v22, v22, v24
    v_add_f32 v23, v23, v25
    v_add_f32 v10, v10, v14
    v_add_f32 v11, v11, v15
    v_add_f32 v18, v18, v22
    v_add_f32 v19, v19, v23
    v_add_f32 v4, v10, v18
    v_add_f32 v6, v11, v19
    v_mov_b32 v5, s42
    v_mov_b32 v7, s42
    buffer_store_dwordx4 v[4:7], v8, s[60:63], s4 offen sc0 sc1
    s_nop 1
L_pc_skip_94:
    s_nop 2
    s_setprio 0
    s_mov_b32 s100, 4
    s_branch L_noside_48
L_noslice_49:
    s_nop 2
    s_mov_b32 s100, 1
L_noside_48:
    s_nop 2
    s_cmp_lg_u32 s100, 1
    s_cbranch_scc1 L_noD_97
    s_cmp_lt_u32 s101, 160
    s_cbranch_scc1 L_noD_97
    s_mov_b32 s100, 2
    v_mov_b32 v24, 17956
    s_mov_b32 s96, 0
L_clrspin_98:
    s_nop 2
    ds_read_b32 v25, v24
    s_waitcnt lgkmcnt(0)
    v_readfirstlane_b32 s4, v25
    s_nop 0
    s_cmp_eq_u32 s4, s42
    s_cbranch_scc1 L_clrok_99
    s_sleep 1
    s_add_u32 s96, s96, 1
    s_cmp_lt_u32 s96, 0x400000
    s_cbranch_scc1 L_clrspin_98
L_clrok_99:
    s_nop 2
    s_cmp_lg_u32 s3, 1
    s_cbranch_scc1 L_noD_97
    s_and_b32 s4, s2, 3
    s_cmp_lg_u32 s4, 1
    s_cbranch_scc1 L_noD_97
    s_setprio 2
    s_lshr_b32 s74, s2, 2
    s_lshr_b32 s75, s74, 5
    s_and_b32 s76, s74, 31
    v_lshrrev_b32 v3, 4, v1
    v_lshlrev_b32 v3, 16, v3
    v_and_b32 v4, 15, v1
    v_lshl_add_u32 v3, v4, 3, v3
    s_lshl_b32 s4, s75, 12
    s_lshl_b32 s5, s76, 7
    s_add_u32 s4, s4, s5
    s_add_u32 s4, s4, 0x300000
    s_mov_b32 s96, 0
L_pd_poll_100:
    s_nop 2
    s_mov_b32 s5, s4
    buffer_load_dwordx2 v[224:225], v3, s[60:63], s5 offen sc0 sc1
    s_add_u32 s5, s5, 8192
    buffer_load_dwordx2 v[226:227], v3, s[60:63], s5 offen sc0 sc1
    s_add_u32 s5, s5, 8192
    buffer_load_dwordx2 v[228:229], v3, s[60:63], s5 offen sc0 sc1
    s_add_u32 s5, s5, 8192
    buffer_load_dwordx2 v[230:231], v3, s[60:63], s5 offen sc0 sc1
    s_add_u32 s5, s5, 8192
    buffer_load_dwordx2 v[232:233], v3, s[60:63], s5 offen sc0 sc1
    s_add_u32 s5, s5, 8192
    buffer_load_dwordx2 v[234:235], v3, s[60:63], s5 offen sc0 sc1
    s_add_u32 s5, s5, 8192
    buffer_load_dwordx2 v[236:237], v3, s[60:63], s5 offen sc0 sc1
    s_add_u32 s5, s5, 8192
    buffer_load_dwordx2 v[238:239], v3, s[60:63], s5 offen sc0 sc1
    s_waitcnt vmcnt(0)
    v_xor_b32 v24, s42, v225
    v_xor_b32 v25, s42, v227
    v_or_b32 v24, v24, v25
    v_xor_b32 v25, s42, v229
    v_or_b32 v24, v24, v25
    v_xor_b32 v25, s42, v231
    v_or_b32 v24, v24, v25
    v_xor_b32 v25, s42, v233
    v_or_b32 v24, v24, v25
    v_xor_b32 v25, s42, v235
    v_or_b32 v24, v24, v25
    v_xor_b32 v25, s42, v237
    v_or_b32 v24, v24, v25
    v_xor_b32 v25, s42, v239
    v_or_b32 v24, v24, v25
    v_cmp_ne_u32 vcc, 0, v24
    s_nop 0
    s_cmp_eq_u64 vcc, 0
    s_cbranch_scc1 L_pd_ok_101
    s_sleep 64
    s_add_u32 s96, s96, 1
    s_cmp_lt_u32 s96, 0x20000
    s_cbranch_scc1 L_pd_poll_100
L_pd_ok_101:
    s_nop 2
    v_add_f32 v5, v224, v226
    v_add_f32 v5, v5, v228
    v_add_f32 v5, v5, v230
    v_add_f32 v5, v5, v232
    v_add_f32 v5, v5, v234
    v_add_f32 v5, v5, v236
    v_add_f32 v5, v5, v238
    v_mov_b32 v6, v5
    s_nop 1
    v_permlane16_swap_b32 v5, v6
    s_nop 0
    v_add_f32 v5, v5, v6
    v_mov_b32 v6, v5
    s_nop 1
    v_permlane32_swap_b32 v5, v6
    s_nop 0
    v_add_f32 v5, v5, v6
    s_nop 1
    v_mov_b32_dpp v6, v5 quad_perm:[1,0,3,2] row_mask:0xf bank_mask:0xf
    v_cvt_pk_bf16_f32 v7, v5, v6
    s_mov_b32 s64, s36
    s_and_b32 s65, s37, 0xffff
    s_mov_b32 s66, 0x1000
    s_mov_b32 s67, 0x00020000
    s_lshl_b32 s4, s75, 11
    s_lshl_b32 s5, s76, 5
    s_add_u32 s4, s4, s5
    s_add_u32 s4, s4, 0
    v_lshlrev_b32 v3, 1, v1
    s_mov_b64 s[94:95], exec
    s_mov_b64 exec, 0x5555
    buffer_store_dword v7, v3, s[64:67], s4 offen
    s_mov_b64 exec, s[94:95]
    s_setprio 0
L_noD_97:
    s_nop 2
    s_branch L_bloop
L_drain0:
    s_nop 2
    v_add_f32_dpp v7, v3, v3 row_ror:8 row_mask:0xf bank_mask:0x3
    v_add_f32_dpp v7, v4, v4 row_ror:8 row_mask:0xf bank_mask:0xc
    v_add_f32_dpp v8, v5, v5 row_ror:8 row_mask:0xf bank_mask:0x3
    v_add_f32_dpp v8, v6, v6 row_ror:8 row_mask:0xf bank_mask:0xc
    v_add_f32_dpp v9, v7, v7 row_half_mirror row_mask:0xf bank_mask:0x5
    s_nop 0
    v_add_f32_dpp v9, v8, v8 row_half_mirror row_mask:0xf bank_mask:0xa
    s_nop 1
    v_add_f32_dpp v9, v9, v9 quad_perm:[1,0,3,2] row_mask:0xf bank_mask:0xf
    s_nop 1
    v_add_f32_dpp v9, v9, v9 quad_perm:[2,3,0,1] row_mask:0xf bank_mask:0xf
    s_nop 1
    v_max_f32_dpp v10, v9, v9 row_half_mirror row_mask:0xf bank_mask:0xf
    s_nop 1
    v_max_f32_dpp v10, v10, v10 row_ror:8 row_mask:0xf bank_mask:0xf
    v_max_f32 v10, v10, v56
    v_sub_f32 v12, v56, v10
    v_mul_f32 v13, s43, v10
    v_mul_f32 v12, s43, v12
    v_fma_f32 v13, v9, s43, -v13
    v_exp_f32 v11, v12
    v_exp_f32 v13, v13
    v_mov_b32 v56, v10
    v_cvt_pk_bf16_f32 v14, v13, 0
    v_lshlrev_b32 v15, 16, v14
    v_mul_f32 v40, v11, v40
    v_mul_f32 v41, v11, v41
    v_mul_f32 v42, v11, v42
    v_mul_f32 v43, v11, v43
    v_mul_f32 v44, v11, v44
    v_mul_f32 v45, v11, v45
    v_mul_f32 v46, v11, v46
    v_mul_f32 v47, v11, v47
    v_fma_f32 v57, v57, v11, v15
    s_waitcnt vmcnt(8)
    v_dot2c_f32_bf16_dpp v40, v14, v144 row_newbcast:0 row_mask:0xf bank_mask:0xf
    v_dot2c_f32_bf16_dpp v41, v15, v144 row_newbcast:0 row_mask:0xf bank_mask:0xf
    v_dot2c_f32_bf16_dpp v42, v14, v145 row_newbcast:0 row_mask:0xf bank_mask:0xf
    v_dot2c_f32_bf16_dpp v43, v15, v145 row_newbcast:0 row_mask:0xf bank_mask:0xf
    v_dot2c_f32_bf16_dpp v44, v14, v146 row_newbcast:0 row_mask:0xf bank_mask:0xf
    v_dot2c_f32_bf16_dpp v45, v15, v146 row_newbcast:0 row_mask:0xf bank_mask:0xf
    v_dot2c_f32_bf16_dpp v46, v14, v147 row_newbcast:0 row_mask:0xf bank_mask:0xf
    v_dot2c_f32_bf16_dpp v47, v15, v147 row_newbcast:0 row_mask:0xf bank_mask:0xf
    v_dot2c_f32_bf16_dpp v40, v14, v148 row_newbcast:8 row_mask:0xf bank_mask:0xf
    v_dot2c_f32_bf16_dpp v41, v15, v148 row_newbcast:8 row_mask:0xf bank_mask:0xf
    v_dot2c_f32_bf16_dpp v42, v14, v149 row_newbcast:8 row_mask:0xf bank_mask:0xf
    v_dot2c_f32_bf16_dpp v43, v15, v149 row_newbcast:8 row_mask:0xf bank_mask:0xf
    v_dot2c_f32_bf16_dpp v44, v14, v150 row_newbcast:8 row_mask:0xf bank_mask:0xf
    v_dot2c_f32_bf16_dpp v45, v15, v150 row_newbcast:8 row_mask:0xf bank_mask:0xf
    v_dot2c_f32_bf16_dpp v46, v14, v151 row_newbcast:8 row_mask:0xf bank_mask:0xf
    v_dot2c_f32_bf16_dpp v47, v15, v151 row_newbcast:8 row_mask:0xf bank_mask:0xf
    v_dot2c_f32_bf16_dpp v40, v14, v152 row_newbcast:4 row_mask:0xf bank_mask:0xf
    v_dot2c_f32_bf16_dpp v41, v15, v152 row_newbcast:4 row_mask:0xf bank_mask:0xf
    v_dot2c_f32_bf16_dpp v42, v14, v153 row_newbcast:4 row_mask:0xf bank_mask:0xf
    v_dot2c_f32_bf16_dpp v43, v15, v153 row_newbcast:4 row_mask:0xf bank_mask:0xf
    v_dot2c_f32_bf16_dpp v44, v14, v154 row_newbcast:4 row_mask:0xf bank_mask:0xf
    v_dot2c_f32_bf16_dpp v45, v15, v154 row_newbcast:4 row_mask:0xf bank_mask:0xf
    v_dot2c_f32_bf16_dpp v46, v14, v155 row_newbcast:4 row_mask:0xf bank_mask:0xf
    v_dot2c_f32_bf16_dpp v47, v15, v155 row_newbcast:4 row_mask:0xf bank_mask:0xf
    v_dot2c_f32_bf16_dpp v40, v14, v156 row_newbcast:12 row_mask:0xf bank_mask:0xf
    v_dot2c_f32_bf16_dpp v41, v15, v156 row_newbcast:12 row_mask:0xf bank_mask:0xf
    v_dot2c_f32_bf16_dpp v42, v14, v157 row_newbcast:12 row_mask:0xf bank_mask:0xf
    v_dot2c_f32_bf16_dpp v43, v15, v157 row_newbcast:12 row_mask:0xf bank_mask:0xf
    v_dot2c_f32_bf16_dpp v44, v14, v158 row_newbcast:12 row_mask:0xf bank_mask:0xf
    v_dot2c_f32_bf16_dpp v45, v15, v158 row_newbcast:12 row_mask:0xf bank_mask:0xf
    v_dot2c_f32_bf16_dpp v46, v14, v159 row_newbcast:12 row_mask:0xf bank_mask:0xf
    v_dot2c_f32_bf16_dpp v47, v15, v159 row_newbcast:12 row_mask:0xf bank_mask:0xf
    s_cmp_eq_u32 s86, s87
    s_cbranch_scc1 L_noswap_102
    v_swap_b32 v32, v36
    v_swap_b32 v33, v37
    v_swap_b32 v34, v38
    v_swap_b32 v35, v39
    v_swap_b32 v40, v48
    v_swap_b32 v41, v49
    v_swap_b32 v42, v50
    v_swap_b32 v43, v51
    v_swap_b32 v44, v52
    v_swap_b32 v45, v53
    v_swap_b32 v46, v54
    v_swap_b32 v47, v55
    v_swap_b32 v56, v58
    v_swap_b32 v57, v59
    s_mov_b32 s87, s86
    s_mov_b32 s99, 1
L_noswap_102:
    s_nop 2
    s_waitcnt vmcnt(4)
    v_dot2_f32_bf16 v3, v160, v32, 0
    v_dot2_f32_bf16 v4, v164, v32, 0
    v_dot2_f32_bf16 v5, v168, v32, 0
    v_dot2_f32_bf16 v6, v172, v32, 0
    v_dot2_f32_bf16 v3, v161, v33, v3
    v_dot2_f32_bf16 v4, v165, v33, v4
    v_dot2_f32_bf16 v5, v169, v33, v5
    v_dot2_f32_bf16 v6, v173, v33, v6
    v_dot2_f32_bf16 v3, v162, v34, v3
    v_dot2_f32_bf16 v4, v166, v34, v4
    v_dot2_f32_bf16 v5, v170, v34, v5
    v_dot2_f32_bf16 v6, v174, v34, v6
    v_dot2_f32_bf16 v3, v163, v35, v3
    v_dot2_f32_bf16 v4, v167, v35, v4
    v_dot2_f32_bf16 v5, v171, v35, v5
    v_dot2_f32_bf16 v6, v175, v35, v6
    s_nop 0
    v_add_f32_dpp v7, v3, v3 row_ror:8 row_mask:0xf bank_mask:0x3
    v_add_f32_dpp v7, v4, v4 row_ror:8 row_mask:0xf bank_mask:0xc
    v_add_f32_dpp v8, v5, v5 row_ror:8 row_mask:0xf bank_mask:0x3
    v_add_f32_dpp v8, v6, v6 row_ror:8 row_mask:0xf bank_mask:0xc
    v_add_f32_dpp v9, v7, v7 row_half_mirror row_mask:0xf bank_mask:0x5
    s_nop 0
    v_add_f32_dpp v9, v8, v8 row_half_mirror row_mask:0xf bank_mask:0xa
    s_nop 1
    v_add_f32_dpp v9, v9, v9 quad_perm:[1,0,3,2] row_mask:0xf bank_mask:0xf
    s_nop 1
    v_add_f32_dpp v9, v9, v9 quad_perm:[2,3,0,1] row_mask:0xf bank_mask:0xf
    s_nop 1
    v_max_f32_dpp v10, v9, v9 row_half_mirror row_mask:0xf bank_mask:0xf
    s_nop 1
    v_max_f32_dpp v10, v10, v10 row_ror:8 row_mask:0xf bank_mask:0xf
    v_max_f32 v10, v10, v56
    v_sub_f32 v12, v56, v10
    v_mul_f32 v13, s43, v10
    v_mul_f32 v12, s43, v12
    v_fma_f32 v13, v9, s43, -v13
    v_exp_f32 v11, v12
    v_exp_f32 v13, v13
    v_mov_b32 v56, v10
    v_cvt_pk_bf16_f32 v14, v13, 0
    v_lshlrev_b32 v15, 16, v14
    v_mul_f32 v40, v11, v40
    v_mul_f32 v41, v11, v41
    v_mul_f32 v42, v11, v42
    v_mul_f32 v43, v11, v43
    v_mul_f32 v44, v11, v44
    v_mul_f32 v45, v11, v45
    v_mul_f32 v46, v11, v46
    v_mul_f32 v47, v11, v47
    v_fma_f32 v57, v57, v11, v15
    s_waitcnt vmcnt(0)
    v_dot2c_f32_bf16_dpp v40, v14, v176 row_newbcast:0 row_mask:0xf bank_mask:0xf
    v_dot2c_f32_bf16_dpp v41, v15, v176 row_newbcast:0 row_mask:0xf bank_mask:0xf
    v_dot2c_f32_bf16_dpp v42, v14, v177 row_newbcast:0 row_mask:0xf bank_mask:0xf
    v_dot2c_f32_bf16_dpp v43, v15, v177 row_newbcast:0 row_mask:0xf bank_mask:0xf
    v_dot2c_f32_bf16_dpp v44, v14, v178 row_newbcast:0 row_mask:0xf bank_mask:0xf
    v_dot2c_f32_bf16_dpp v45, v15, v178 row_newbcast:0 row_mask:0xf bank_mask:0xf
    v_dot2c_f32_bf16_dpp v46, v14, v179 row_newbcast:0 row_mask:0xf bank_mask:0xf
    v_dot2c_f32_bf16_dpp v47, v15, v179 row_newbcast:0 row_mask:0xf bank_mask:0xf
    v_dot2c_f32_bf16_dpp v40, v14, v180 row_newbcast:8 row_mask:0xf bank_mask:0xf
    v_dot2c_f32_bf16_dpp v41, v15, v180 row_newbcast:8 row_mask:0xf bank_mask:0xf
    v_dot2c_f32_bf16_dpp v42, v14, v181 row_newbcast:8 row_mask:0xf bank_mask:0xf
    v_dot2c_f32_bf16_dpp v43, v15, v181 row_newbcast:8 row_mask:0xf bank_mask:0xf
    v_dot2c_f32_bf16_dpp v44, v14, v182 row_newbcast:8 row_mask:0xf bank_mask:0xf
    v_dot2c_f32_bf16_dpp v45, v15, v182 row_newbcast:8 row_mask:0xf bank_mask:0xf
    v_dot2c_f32_bf16_dpp v46, v14, v183 row_newbcast:8 row_mask:0xf bank_mask:0xf
    v_dot2c_f32_bf16_dpp v47, v15, v183 row_newbcast:8 row_mask:0xf bank_mask:0xf
    v_dot2c_f32_bf16_dpp v40, v14, v184 row_newbcast:4 row_mask:0xf bank_mask:0xf
    v_dot2c_f32_bf16_dpp v41, v15, v184 row_newbcast:4 row_mask:0xf bank_mask:0xf
    v_dot2c_f32_bf16_dpp v42, v14, v185 row_newbcast:4 row_mask:0xf bank_mask:0xf
    v_dot2c_f32_bf16_dpp v43, v15, v185 row_newbcast:4 row_mask:0xf bank_mask:0xf
    v_dot2c_f32_bf16_dpp v44, v14, v186 row_newbcast:4 row_mask:0xf bank_mask:0xf
    v_dot2c_f32_bf16_dpp v45, v15, v186 row_newbcast:4 row_mask:0xf bank_mask:0xf
    v_dot2c_f32_bf16_dpp v46, v14, v187 row_newbcast:4 row_mask:0xf bank_mask:0xf
    v_dot2c_f32_bf16_dpp v47, v15, v187 row_newbcast:4 row_mask:0xf bank_mask:0xf
    v_dot2c_f32_bf16_dpp v40, v14, v188 row_newbcast:12 row_mask:0xf bank_mask:0xf
    v_dot2c_f32_bf16_dpp v41, v15, v188 row_newbcast:12 row_mask:0xf bank_mask:0xf
    v_dot2c_f32_bf16_dpp v42, v14, v189 row_newbcast:12 row_mask:0xf bank_mask:0xf
    v_dot2c_f32_bf16_dpp v43, v15, v189 row_newbcast:12 row_mask:0xf bank_mask:0xf
    v_dot2c_f32_bf16_dpp v44, v14, v190 row_newbcast:12 row_mask:0xf bank_mask:0xf
    v_dot2c_f32_bf16_dpp v45, v15, v190 row_newbcast:12 row_mask:0xf bank_mask:0xf
    v_dot2c_f32_bf16_dpp v46, v14, v191 row_newbcast:12 row_mask:0xf bank_mask:0xf
    v_dot2c_f32_bf16_dpp v47, v15, v191 row_newbcast:12 row_mask:0xf bank_mask:0xf
    s_branch L_tail
L_drain1:
    s_nop 2
    v_add_f32_dpp v7, v3, v3 row_ror:8 row_mask:0xf bank_mask:0x3
    v_add_f32_dpp v7, v4, v4 row_ror:8 row_mask:0xf bank_mask:0xc
    v_add_f32_dpp v8, v5, v5 row_ror:8 row_mask:0xf bank_mask:0x3
    v_add_f32_dpp v8, v6, v6 row_ror:8 row_mask:0xf bank_mask:0xc
    v_add_f32_dpp v9, v7, v7 row_half_mirror row_mask:0xf bank_mask:0x5
    s_nop 0
    v_add_f32_dpp v9, v8, v8 row_half_mirror row_mask:0xf bank_mask:0xa
    s_nop 1
    v_add_f32_dpp v9, v9, v9 quad_perm:[1,0,3,2] row_mask:0xf bank_mask:0xf
    s_nop 1
    v_add_f32_dpp v9, v9, v9 quad_perm:[2,3,0,1] row_mask:0xf bank_mask:0xf
    s_nop 1
    v_max_f32_dpp v10, v9, v9 row_half_mirror row_mask:0xf bank_mask:0xf
    s_nop 1
    v_max_f32_dpp v10, v10, v10 row_ror:8 row_mask:0xf bank_mask:0xf
    v_max_f32 v10, v10, v56
    v_sub_f32 v12, v56, v10
    v_mul_f32 v13, s43, v10
    v_mul_f32 v12, s43, v12
    v_fma_f32 v13, v9, s43, -v13
    v_exp_f32 v11, v12
    v_exp_f32 v13, v13
    v_mov_b32 v56, v10
    v_cvt_pk_bf16_f32 v14, v13, 0
    v_lshlrev_b32 v15, 16, v14
    v_mul_f32 v40, v11, v40
    v_mul_f32 v41, v11, v41
    v_mul_f32 v42, v11, v42
    v_mul_f32 v43, v11, v43
    v_mul_f32 v44, v11, v44
    v_mul_f32 v45, v11, v45
    v_mul_f32 v46, v11, v46
    v_mul_f32 v47, v11, v47
    v_fma_f32 v57, v57, v11, v15
    s_waitcnt vmcnt(8)
    v_dot2c_f32_bf16_dpp v40, v14, v176 row_newbcast:0 row_mask:0xf bank_mask:0xf
    v_dot2c_f32_bf16_dpp v41, v15, v176 row_newbcast:0 row_mask:0xf bank_mask:0xf
    v_dot2c_f32_bf16_dpp v42, v14, v177 row_newbcast:0 row_mask:0xf bank_mask:0xf
    v_dot2c_f32_bf16_dpp v43, v15, v177 row_newbcast:0 row_mask:0xf bank_mask:0xf
    v_dot2c_f32_bf16_dpp v44, v14, v178 row_newbcast:0 row_mask:0xf bank_mask:0xf
    v_dot2c_f32_bf16_dpp v45, v15, v178 row_newbcast:0 row_mask:0xf bank_mask:0xf
    v_dot2c_f32_bf16_dpp v46, v14, v179 row_newbcast:0 row_mask:0xf bank_mask:0xf
    v_dot2c_f32_bf16_dpp v47, v15, v179 row_newbcast:0 row_mask:0xf bank_mask:0xf
    v_dot2c_f32_bf16_dpp v40, v14, v180 row_newbcast:8 row_mask:0xf bank_mask:0xf
    v_dot2c_f32_bf16_dpp v41, v15, v180 row_newbcast:8 row_mask:0xf bank_mask:0xf
    v_dot2c_f32_bf16_dpp v42, v14, v181 row_newbcast:8 row_mask:0xf bank_mask:0xf
    v_dot2c_f32_bf16_dpp v43, v15, v181 row_newbcast:8 row_mask:0xf bank_mask:0xf
    v_dot2c_f32_bf16_dpp v44, v14, v182 row_newbcast:8 row_mask:0xf bank_mask:0xf
    v_dot2c_f32_bf16_dpp v45, v15, v182 row_newbcast:8 row_mask:0xf bank_mask:0xf
    v_dot2c_f32_bf16_dpp v46, v14, v183 row_newbcast:8 row_mask:0xf bank_mask:0xf
    v_dot2c_f32_bf16_dpp v47, v15, v183 row_newbcast:8 row_mask:0xf bank_mask:0xf
    v_dot2c_f32_bf16_dpp v40, v14, v184 row_newbcast:4 row_mask:0xf bank_mask:0xf
    v_dot2c_f32_bf16_dpp v41, v15, v184 row_newbcast:4 row_mask:0xf bank_mask:0xf
    v_dot2c_f32_bf16_dpp v42, v14, v185 row_newbcast:4 row_mask:0xf bank_mask:0xf
    v_dot2c_f32_bf16_dpp v43, v15, v185 row_newbcast:4 row_mask:0xf bank_mask:0xf
    v_dot2c_f32_bf16_dpp v44, v14, v186 row_newbcast:4 row_mask:0xf bank_mask:0xf
    v_dot2c_f32_bf16_dpp v45, v15, v186 row_newbcast:4 row_mask:0xf bank_mask:0xf
    v_dot2c_f32_bf16_dpp v46, v14, v187 row_newbcast:4 row_mask:0xf bank_mask:0xf
    v_dot2c_f32_bf16_dpp v47, v15, v187 row_newbcast:4 row_mask:0xf bank_mask:0xf
    v_dot2c_f32_bf16_dpp v40, v14, v188 row_newbcast:12 row_mask:0xf bank_mask:0xf
    v_dot2c_f32_bf16_dpp v41, v15, v188 row_newbcast:12 row_mask:0xf bank_mask:0xf
    v_dot2c_f32_bf16_dpp v42, v14, v189 row_newbcast:12 row_mask:0xf bank_mask:0xf
    v_dot2c_f32_bf16_dpp v43, v15, v189 row_newbcast:12 row_mask:0xf bank_mask:0xf
    v_dot2c_f32_bf16_dpp v44, v14, v190 row_newbcast:12 row_mask:0xf bank_mask:0xf
    v_dot2c_f32_bf16_dpp v45, v15, v190 row_newbcast:12 row_mask:0xf bank_mask:0xf
    v_dot2c_f32_bf16_dpp v46, v14, v191 row_newbcast:12 row_mask:0xf bank_mask:0xf
    v_dot2c_f32_bf16_dpp v47, v15, v191 row_newbcast:12 row_mask:0xf bank_mask:0xf
    s_cmp_eq_u32 s85, s87
    s_cbranch_scc1 L_noswap_103
    v_swap_b32 v32, v36
    v_swap_b32 v33, v37
    v_swap_b32 v34, v38
    v_swap_b32 v35, v39
    v_swap_b32 v40, v48
    v_swap_b32 v41, v49
    v_swap_b32 v42, v50
    v_swap_b32 v43, v51
    v_swap_b32 v44, v52
    v_swap_b32 v45, v53
    v_swap_b32 v46, v54
    v_swap_b32 v47, v55
    v_swap_b32 v56, v58
    v_swap_b32 v57, v59
    s_mov_b32 s87, s85
    s_mov_b32 s99, 1
L_noswap_103:
    s_nop 2
    s_waitcnt vmcnt(4)
    v_dot2_f32_bf16 v3, v128, v32, 0
    v_dot2_f32_bf16 v4, v132, v32, 0
    v_dot2_f32_bf16 v5, v136, v32, 0
    v_dot2_f32_bf16 v6, v140, v32, 0
    v_dot2_f32_bf16 v3, v129, v33, v3
    v_dot2_f32_bf16 v4, v133, v33, v4
    v_dot2_f32_bf16 v5, v137, v33, v5
    v_dot2_f32_bf16 v6, v141, v33, v6
    v_dot2_f32_bf16 v3, v130, v34, v3
    v_dot2_f32_bf16 v4, v134, v34, v4
    v_dot2_f32_bf16 v5, v138, v34, v5
    v_dot2_f32_bf16 v6, v142, v34, v6
    v_dot2_f32_bf16 v3, v131, v35, v3
    v_dot2_f32_bf16 v4, v135, v35, v4
    v_dot2_f32_bf16 v5, v139, v35, v5
    v_dot2_f32_bf16 v6, v143, v35, v6
    s_nop 0
    v_add_f32_dpp v7, v3, v3 row_ror:8 row_mask:0xf bank_mask:0x3
    v_add_f32_dpp v7, v4, v4 row_ror:8 row_mask:0xf bank_mask:0xc
    v_add_f32_dpp v8, v5, v5 row_ror:8 row_mask:0xf bank_mask:0x3
    v_add_f32_dpp v8, v6, v6 row_ror:8 row_mask:0xf bank_mask:0xc
    v_add_f32_dpp v9, v7, v7 row_half_mirror row_mask:0xf bank_mask:0x5
    s_nop 0
    v_add_f32_dpp v9, v8, v8 row_half_mirror row_mask:0xf bank_mask:0xa
    s_nop 1
    v_add_f32_dpp v9, v9, v9 quad_perm:[1,0,3,2] row_mask:0xf bank_mask:0xf
    s_nop 1
    v_add_f32_dpp v9, v9, v9 quad_perm:[2,3,0,1] row_mask:0xf bank_mask:0xf
    s_nop 1
    v_max_f32_dpp v10, v9, v9 row_half_mirror row_mask:0xf bank_mask:0xf
    s_nop 1
    v_max_f32_dpp v10, v10, v10 row_ror:8 row_mask:0xf bank_mask:0xf
    v_max_f32 v10, v10, v56
    v_sub_f32 v12, v56, v10
    v_mul_f32 v13, s43, v10
    v_mul_f32 v12, s43, v12
    v_fma_f32 v13, v9, s43, -v13
    v_exp_f32 v11, v12
    v_exp_f32 v13, v13
    v_mov_b32 v56, v10
    v_cvt_pk_bf16_f32 v14, v13, 0
    v_lshlrev_b32 v15, 16, v14
    v_mul_f32 v40, v11, v40
    v_mul_f32 v41, v11, v41
    v_mul_f32 v42, v11, v42
    v_mul_f32 v43, v11, v43
    v_mul_f32 v44, v11, v44
    v_mul_f32 v45, v11, v45
    v_mul_f32 v46, v11, v46
    v_mul_f32 v47, v11, v47
    v_fma_f32 v57, v57, v11, v15
    s_waitcnt vmcnt(0)
    v_dot2c_f32_bf16_dpp v40, v14, v144 row_newbcast:0 row_mask:0xf bank_mask:0xf
    v_dot2c_f32_bf16_dpp v41, v15, v144 row_newbcast:0 row_mask:0xf bank_mask:0xf
    v_dot2c_f32_bf16_dpp v42, v14, v145 row_newbcast:0 row_mask:0xf bank_mask:0xf
    v_dot2c_f32_bf16_dpp v43, v15, v145 row_newbcast:0 row_mask:0xf bank_mask:0xf
    v_dot2c_f32_bf16_dpp v44, v14, v146 row_newbcast:0 row_mask:0xf bank_mask:0xf
    v_dot2c_f32_bf16_dpp v45, v15, v146 row_newbcast:0 row_mask:0xf bank_mask:0xf
    v_dot2c_f32_bf16_dpp v46, v14, v147 row_newbcast:0 row_mask:0xf bank_mask:0xf
    v_dot2c_f32_bf16_dpp v47, v15, v147 row_newbcast:0 row_mask:0xf bank_mask:0xf
    v_dot2c_f32_bf16_dpp v40, v14, v148 row_newbcast:8 row_mask:0xf bank_mask:0xf
    v_dot2c_f32_bf16_dpp v41, v15, v148 row_newbcast:8 row_mask:0xf bank_mask:0xf
    v_dot2c_f32_bf16_dpp v42, v14, v149 row_newbcast:8 row_mask:0xf bank_mask:0xf
    v_dot2c_f32_bf16_dpp v43, v15, v149 row_newbcast:8 row_mask:0xf bank_mask:0xf
    v_dot2c_f32_bf16_dpp v44, v14, v150 row_newbcast:8 row_mask:0xf bank_mask:0xf
    v_dot2c_f32_bf16_dpp v45, v15, v150 row_newbcast:8 row_mask:0xf bank_mask:0xf
    v_dot2c_f32_bf16_dpp v46, v14, v151 row_newbcast:8 row_mask:0xf bank_mask:0xf
    v_dot2c_f32_bf16_dpp v47, v15, v151 row_newbcast:8 row_mask:0xf bank_mask:0xf
    v_dot2c_f32_bf16_dpp v40, v14, v152 row_newbcast:4 row_mask:0xf bank_mask:0xf
    v_dot2c_f32_bf16_dpp v41, v15, v152 row_newbcast:4 row_mask:0xf bank_mask:0xf
    v_dot2c_f32_bf16_dpp v42, v14, v153 row_newbcast:4 row_mask:0xf bank_mask:0xf
    v_dot2c_f32_bf16_dpp v43, v15, v153 row_newbcast:4 row_mask:0xf bank_mask:0xf
    v_dot2c_f32_bf16_dpp v44, v14, v154 row_newbcast:4 row_mask:0xf bank_mask:0xf
    v_dot2c_f32_bf16_dpp v45, v15, v154 row_newbcast:4 row_mask:0xf bank_mask:0xf
    v_dot2c_f32_bf16_dpp v46, v14, v155 row_newbcast:4 row_mask:0xf bank_mask:0xf
    v_dot2c_f32_bf16_dpp v47, v15, v155 row_newbcast:4 row_mask:0xf bank_mask:0xf
    v_dot2c_f32_bf16_dpp v40, v14, v156 row_newbcast:12 row_mask:0xf bank_mask:0xf
    v_dot2c_f32_bf16_dpp v41, v15, v156 row_newbcast:12 row_mask:0xf bank_mask:0xf
    v_dot2c_f32_bf16_dpp v42, v14, v157 row_newbcast:12 row_mask:0xf bank_mask:0xf
    v_dot2c_f32_bf16_dpp v43, v15, v157 row_newbcast:12 row_mask:0xf bank_mask:0xf
    v_dot2c_f32_bf16_dpp v44, v14, v158 row_newbcast:12 row_mask:0xf bank_mask:0xf
    v_dot2c_f32_bf16_dpp v45, v15, v158 row_newbcast:12 row_mask:0xf bank_mask:0xf
    v_dot2c_f32_bf16_dpp v46, v14, v159 row_newbcast:12 row_mask:0xf bank_mask:0xf
    v_dot2c_f32_bf16_dpp v47, v15, v159 row_newbcast:12 row_mask:0xf bank_mask:0xf
    s_branch L_tail
L_tail:
    s_nop 2
    s_cmp_eq_u32 s100, 2
    s_cbranch_scc1 L_tclr_104
    v_mov_b32 v24, 17956
    s_mov_b32 s96, 0
L_clrspin_105:
    s_nop 2
    ds_read_b32 v25, v24
    s_waitcnt lgkmcnt(0)
    v_readfirstlane_b32 s4, v25
    s_nop 0
    s_cmp_eq_u32 s4, s42
    s_cbranch_scc1 L_clrok_106
    s_sleep 1
    s_add_u32 s96, s96, 1
    s_cmp_lt_u32 s96, 0x400000
    s_cbranch_scc1 L_clrspin_105
L_clrok_106:
    s_nop 2
L_tclr_104:
    s_nop 2
    s_cmp_eq_u32 s89, 0
    s_cbranch_scc1 L_noreq_107
    s_waitcnt lgkmcnt(0)
    s_mov_b32 s96, 0
L_rqretry_108:
    s_nop 2
    s_cmp_eq_u32 s91, s42
    s_cbranch_scc1 L_rqok_109
    s_sleep 8
    s_mov_b32 s90, 1
    s_mov_b32 s91, 0
    s_atomic_add_x2 s[90:91], s[92:93], 0 glc
    s_waitcnt lgkmcnt(0)
    s_add_u32 s96, s96, 1
    s_cmp_lt_u32 s96, 0x20000
    s_cbranch_scc1 L_rqretry_108
L_rqok_109:
    s_nop 2
    s_sub_u32 s4, s89, 1
    s_lshl_b32 s4, s4, 2
    v_mov_b32 v24, s4
    v_mov_b32 v25, s90
    ds_write_b32 v24, v25 offset:19392
    s_mov_b32 s89, 0
L_noreq_107:
    s_nop 2
    s_cmp_eq_u32 s100, 32
    s_cbranch_scc1 L_l1pend_113
    s_cmp_lg_u32 s100, 0
    s_cbranch_scc1 L_sidechk_114
    v_mov_b32 v25, 17952
    v_mov_b32 v24, 1
    s_mov_b64 s[94:95], exec
    s_mov_b64 exec, 1
    ds_add_rtn_u32 v24, v25, v24
    s_mov_b64 exec, s[94:95]
    s_waitcnt lgkmcnt(0)
    v_readfirstlane_b32 s4, v24
    s_nop 3
    s_cmp_lg_u32 s4, 0
    s_cbranch_scc1 L_sideloop_111
L_l1pend_113:
    s_nop 2
    v_lshrrev_b32 v3, 5, v1
    v_lshrrev_b32 v4, 2, v1
    v_and_b32 v4, 7, v4
    v_lshlrev_b32 v3, 9, v3
    v_add_u32 v3, v3, v4
    s_lshl_b32 s74, s72, 4
    v_add_u32 v3, s74, v3
    v_lshlrev_b32 v5, 4, v3
    v_lshlrev_b32 v6, 10, v3
    v_and_b32 v4, 3, v1
    v_lshl_add_u32 v6, v4, 5, v6
    s_lshl_b32 s74, s73, 7
    s_add_u32 s74, s74, 0x100000
    s_mov_b32 s75, 0x20000
    s_add_u32 s76, s74, 8192
    s_add_u32 s77, s75, 128
    s_mov_b32 s96, 0
L_pc_poll_116:
    s_nop 2
    buffer_load_dwordx4 v[224:227], v6, s[60:63], s74 offen sc0 sc1
    buffer_load_dwordx4 v[228:231], v6, s[60:63], s74 offen offset:16 sc0 sc1
    buffer_load_dwordx4 v[232:235], v5, s[60:63], s75 offen sc0 sc1
    buffer_load_dwordx4 v[236:239], v6, s[60:63], s76 offen sc0 sc1
    buffer_load_dwordx4 v[240:243], v6, s[60:63], s76 offen offset:16 sc0 sc1
    buffer_load_dwordx4 v[244:247], v5, s[60:63], s77 offen sc0 sc1
    s_waitcnt vmcnt(0)
    s_mov_b64 exec, -1
    v_xor_b32 v24, s42, v225
    v_xor_b32 v25, s42, v227
    v_or_b32 v24, v24, v25
    v_xor_b32 v25, s42, v229
    v_or_b32 v24, v24, v25
    v_xor_b32 v25, s42, v231
    v_or_b32 v24, v24, v25
    v_xor_b32 v25, s42, v233
    v_or_b32 v24, v24, v25
    v_xor_b32 v25, s42, v235
    v_or_b32 v24, v24, v25
    v_xor_b32 v25, s42, v237
    v_or_b32 v24, v24, v25
    v_xor_b32 v25, s42, v239
    v_or_b32 v24, v24, v25
    v_xor_b32 v25, s42, v241
    v_or_b32 v24, v24, v25
    v_xor_b32 v25, s42, v243
    v_or_b32 v24, v24, v25
    v_xor_b32 v25, s42, v245
    v_or_b32 v24, v24, v25
    v_xor_b32 v25, s42, v247
    v_or_b32 v24, v24, v25
    v_cmp_ne_u32 vcc, 0, v24
    s_nop 0
    s_cmp_eq_u64 vcc, 0
    s_cbranch_scc1 L_pc_ok_115
    s_sleep 64
    s_add_u32 s96, s96, 1
    s_cmp_lt_u32 s96, 0x20000
    s_cbranch_scc1 L_pc_poll_116
    s_mov_b64 exec, -1
L_pc_ok_115:
    s_nop 2
    v_max_f32 v3, v232, v244
    s_nop 1
    v_max_f32_dpp v3, v3, v3 row_ror:4 row_mask:0xf bank_mask:0xf
    s_nop 1
    v_max_f32_dpp v3, v3, v3 row_ror:8 row_mask:0xf bank_mask:0xf
    v_mov_b32 v4, v3
    s_nop 1
    v_permlane16_swap_b32 v3, v4
    s_nop 0
    v_max_f32 v3, v3, v4
    v_sub_f32 v4, v232, v3
    v_mul_f32 v4, s43, v4
    v_exp_f32 v4, v4
    v_sub_f32 v5, v244, v3
    v_mul_f32 v5, s43, v5
    v_exp_f32 v5, v5
    s_nop 0
    v_mul_f32 v6, v4, v224
    v_fmac_f32 v6, v5, v236
    v_mul_f32 v7, v4, v226
    v_fmac_f32 v7, v5, v238
    v_mul_f32 v8, v4, v228
    v_fmac_f32 v8, v5, v240
    v_mul_f32 v9, v4, v230
    v_fmac_f32 v9, v5, v242
    v_mul_f32 v10, v4, v234
    v_fmac_f32 v10, v5, v246
    s_nop 0
    v_add_f32_dpp v6, v6, v6 row_ror:4 row_mask:0xf bank_mask:0xf
    v_add_f32_dpp v7, v7, v7 row_ror:4 row_mask:0xf bank_mask:0xf
    v_add_f32_dpp v8, v8, v8 row_ror:4 row_mask:0xf bank_mask:0xf
    v_add_f32_dpp v9, v9, v9 row_ror:4 row_mask:0xf bank_mask:0xf
    v_add_f32_dpp v10, v10, v10 row_ror:4 row_mask:0xf bank_mask:0xf
    v_add_f32_dpp v6, v6, v6 row_ror:8 row_mask:0xf bank_mask:0xf
    v_add_f32_dpp v7, v7, v7 row_ror:8 row_mask:0xf bank_mask:0xf
    v_add_f32_dpp v8, v8, v8 row_ror:8 row_mask:0xf bank_mask:0xf
    v_add_f32_dpp v9, v9, v9 row_ror:8 row_mask:0xf bank_mask:0xf
    v_add_f32_dpp v10, v10, v10 row_ror:8 row_mask:0xf bank_mask:0xf
    v_mov_b32 v11, v6
    v_mov_b32 v12, v7
    v_mov_b32 v13, v8
    v_mov_b32 v14, v9
    v_mov_b32 v15, v10
    s_nop 0
    v_permlane16_swap_b32 v6, v11
    v_permlane16_swap_b32 v7, v12
    v_permlane16_swap_b32 v8, v13
    v_permlane16_swap_b32 v9, v14
    v_permlane16_swap_b32 v10, v15
    s_nop 0
    v_add_f32 v6, v6, v11
    v_add_f32 v7, v7, v12
    v_add_f32 v8, v8, v13
    v_add_f32 v9, v9, v14
    v_add_f32 v10, v10, v15
    v_rcp_f32 v10, v10
    s_nop 0
    v_mul_f32 v6, v10, v6
    v_mul_f32 v7, v10, v7
    v_mul_f32 v8, v10, v8
    v_mul_f32 v9, v10, v9
    v_mov_b32 v24, 17956
    s_mov_b32 s96, 0
L_clrspin_117:
    s_nop 2
    ds_read_b32 v25, v24
    s_waitcnt lgkmcnt(0)
    v_readfirstlane_b32 s4, v25
    s_nop 0
    s_cmp_eq_u32 s4, s42
    s_cbranch_scc1 L_clrok_118
    s_sleep 1
    s_add_u32 s96, s96, 1
    s_cmp_lt_u32 s96, 0x400000
    s_cbranch_scc1 L_clrspin_117
L_clrok_118:
    s_nop 2
    v_mov_b32 v12, v6
    v_mov_b32 v13, s42
    v_mov_b32 v14, v7
    v_mov_b32 v15, s42
    v_mov_b32 v16, v8
    v_mov_b32 v17, s42
    v_mov_b32 v18, v9
    v_mov_b32 v19, s42
    v_lshrrev_b32 v3, 5, v1
    v_lshlrev_b32 v3, 10, v3
    v_and_b32 v4, 3, v1
    v_lshl_add_u32 v3, v4, 5, v3
    s_lshl_b32 s4, s72, 11
    s_lshl_b32 s5, s73, 7
    s_add_u32 s4, s4, s5
    s_add_u32 s4, s4, 0x30000
    v_and_b32 v4, 0x1c, v1
    v_cmp_eq_u32 vcc, 0, v4
    s_nop 0
    s_and_saveexec_b64 s[94:95], vcc
    buffer_store_dwordx4 v[12:15], v3, s[60:63], s4 offen sc0 sc1
    buffer_store_dwordx4 v[16:19], v3, s[60:63], s4 offen offset:16 sc0 sc1
    s_mov_b64 exec, s[94:95]
    s_nop 1
    s_branch L_sideloop_111
L_sidechk_114:
    s_nop 2
    s_cmp_ge_u32 s100, 16
    s_cbranch_scc1 L_sidepend_112
    s_cmp_lg_u32 s100, 4
    s_cbranch_scc1 L_sidedone_110
L_sideloop_111:
    s_nop 2
    v_mov_b32 v25, 17948
    v_mov_b32 v24, 1
    s_mov_b64 s[94:95], exec
    s_mov_b64 exec, 1
    ds_add_rtn_u32 v24, v25, v24
    s_mov_b64 exec, s[94:95]
    s_waitcnt lgkmcnt(0)
    v_readfirstlane_b32 s82, v24
    s_nop 3
    s_cmp_ge_u32 s82, 8
    s_cbranch_scc1 L_sidedone_110
L_sidepend_112:
    s_nop 2
    s_mov_b32 s64, s24
    s_and_b32 s65, s25, 0xffff
    s_mov_b32 s66, 0x400000
    s_mov_b32 s67, 0x00020000
    v_and_b32 v3, 3, v1
    v_lshlrev_b32 v3, 12, v3
    v_lshrrev_b32 v4, 2, v1
    v_and_b32 v4, 7, v4
    v_lshl_add_u32 v3, v4, 4, v3
    s_lshl_b32 s4, s72, 17
    s_lshl_b32 s5, s82, 14
    s_add_u32 s4, s4, s5
    s_lshl_b32 s5, s73, 7
    s_add_u32 s4, s4, s5
    buffer_load_dwordx4 v[192:195], v3, s[64:67], s4 offen offset:0 nt
    buffer_load_dwordx4 v[196:199], v3, s[64:67], s4 offen offset:1024 nt
    buffer_load_dwordx4 v[200:203], v3, s[64:67], s4 offen offset:2048 nt
    buffer_load_dwordx4 v[204:207], v3, s[64:67], s4 offen offset:3072 nt
    v_lshrrev_b32 v3, 5, v1
    v_lshrrev_b32 v4, 2, v1
    v_and_b32 v4, 7, v4
    v_lshlrev_b32 v3, 9, v3
    v_add_u32 v3, v3, v4
    s_lshl_b32 s74, s72, 4
    v_add_u32 v3, s74, v3
    v_lshlrev_b32 v5, 4, v3
    v_lshlrev_b32 v6, 10, v3
    v_and_b32 v4, 3, v1
    v_lshl_add_u32 v6, v4, 5, v6
    s_lshl_b32 s74, s82, 7
    s_add_u32 s74, s74, 0x100000
    s_mov_b32 s75, 0x20000
    s_add_u32 s76, s74, 8192
    s_add_u32 s77, s75, 128
    v_lshrrev_b32 v6, 5, v1
    v_lshlrev_b32 v6, 10, v6
    v_and_b32 v4, 3, v1
    v_lshl_add_u32 v6, v4, 5, v6
    s_lshl_b32 s74, s72, 11
    s_lshl_b32 s75, s82, 7
    s_add_u32 s74, s74, s75
    s_add_u32 s74, s74, 0x30000
    s_mov_b32 s96, 0
L_pc_poll_120:
    s_nop 2
    buffer_load_dwordx4 v[224:227], v6, s[60:63], s74 offen sc0 sc1
    buffer_load_dwordx4 v[228:231], v6, s[60:63], s74 offen offset:16 sc0 sc1
    s_waitcnt vmcnt(0)
    s_mov_b64 exec, -1
    v_xor_b32 v24, s42, v225
    v_xor_b32 v25, s42, v227
    v_or_b32 v24, v24, v25
    v_xor_b32 v25, s42, v229
    v_or_b32 v24, v24, v25
    v_xor_b32 v25, s42, v231
    v_or_b32 v24, v24, v25
    v_cmp_ne_u32 vcc, 0, v24
    s_nop 0
    s_cmp_eq_u64 vcc, 0
    s_cbranch_scc1 L_pc_ok_119
    s_sleep 64
    s_add_u32 s96, s96, 1
    s_cmp_lt_u32 s96, 0x20000
    s_cbranch_scc1 L_pc_poll_120
    s_mov_b64 exec, -1
L_pc_ok_119:
    s_nop 2
    v_mov_b32 v6, v224
    v_mov_b32 v7, v226
    v_mov_b32 v8, v228
    v_mov_b32 v9, v230
    v_cvt_pk_bf16_f32 v16, v6, 0
    v_lshlrev_b32 v17, 16, v16
    v_cvt_pk_bf16_f32 v18, v7, 0
    v_lshlrev_b32 v19, 16, v18
    v_cvt_pk_bf16_f32 v20, v8, 0
    v_lshlrev_b32 v21, 16, v20
    v_cvt_pk_bf16_f32 v22, v9, 0
    v_lshlrev_b32 v23, 16, v22
    v_mov_b32 v6, 0
    v_mov_b32 v7, 0
    v_mov_b32 v8, 0
    v_mov_b32 v9, 0
    v_mov_b32 v10, 0
    v_mov_b32 v11, 0
    v_mov_b32 v12, 0
    v_mov_b32 v13, 0
    v_dot2c_f32_bf16 v6, v16, v192
    v_dot2c_f32_bf16 v7, v17, v192
    v_dot2c_f32_bf16 v8, v16, v193
    v_dot2c_f32_bf16 v9, v17, v193
    v_dot2c_f32_bf16 v10, v16, v194
    v_dot2c_f32_bf16 v11, v17, v194
    v_dot2c_f32_bf16 v12, v16, v195
    v_dot2c_f32_bf16 v13, v17, v195
    v_dot2c_f32_bf16 v6, v18, v196
    v_dot2c_f32_bf16 v7, v19, v196
    v_dot2c_f32_bf16 v8, v18, v197
    v_dot2c_f32_bf16 v9, v19, v197
    v_dot2c_f32_bf16 v10, v18, v198
    v_dot2c_f32_bf16 v11, v19, v198
    v_dot2c_f32_bf16 v12, v18, v199
    v_dot2c_f32_bf16 v13, v19, v199
    v_dot2c_f32_bf16 v6, v20, v200
    v_dot2c_f32_bf16 v7, v21, v200
    v_dot2c_f32_bf16 v8, v20, v201
    v_dot2c_f32_bf16 v9, v21, v201
    v_dot2c_f32_bf16 v10, v20, v202
    v_dot2c_f32_bf16 v11, v21, v202
    v_dot2c_f32_bf16 v12, v20, v203
    v_dot2c_f32_bf16 v13, v21, v203
    v_dot2c_f32_bf16 v6, v22, v204
    v_dot2c_f32_bf16 v7, v23, v204
    v_dot2c_f32_bf16 v8, v22, v205
    v_dot2c_f32_bf16 v9, v23, v205
    v_dot2c_f32_bf16 v10, v22, v206
    v_dot2c_f32_bf16 v11, v23, v206
    v_dot2c_f32_bf16 v12, v22, v207
    v_dot2c_f32_bf16 v13, v23, v207
    v_add_f32_dpp v6, v6, v6 quad_perm:[1,0,3,2] row_mask:0xf bank_mask:0xf
    v_add_f32_dpp v7, v7, v7 quad_perm:[1,0,3,2] row_mask:0xf bank_mask:0xf
    v_add_f32_dpp v8, v8, v8 quad_perm:[1,0,3,2] row_mask:0xf bank_mask:0xf
    v_add_f32_dpp v9, v9, v9 quad_perm:[1,0,3,2] row_mask:0xf bank_mask:0xf
    v_add_f32_dpp v10, v10, v10 quad_perm:[1,0,3,2] row_mask:0xf bank_mask:0xf
    v_add_f32_dpp v11, v11, v11 quad_perm:[1,0,3,2] row_mask:0xf bank_mask:0xf
    v_add_f32_dpp v12, v12, v12 quad_perm:[1,0,3,2] row_mask:0xf bank_mask:0xf
    v_add_f32_dpp v13, v13, v13 quad_perm:[1,0,3,2] row_mask:0xf bank_mask:0xf
    v_add_f32_dpp v6, v6, v6 quad_perm:[2,3,0,1] row_mask:0xf bank_mask:0xf
    v_add_f32_dpp v7, v7, v7 quad_perm:[2,3,0,1] row_mask:0xf bank_mask:0xf
    v_add_f32_dpp v8, v8, v8 quad_perm:[2,3,0,1] row_mask:0xf bank_mask:0xf
    v_add_f32_dpp v9, v9, v9 quad_perm:[2,3,0,1] row_mask:0xf bank_mask:0xf
    v_add_f32_dpp v10, v10, v10 quad_perm:[2,3,0,1] row_mask:0xf bank_mask:0xf
    v_add_f32_dpp v11, v11, v11 quad_perm:[2,3,0,1] row_mask:0xf bank_mask:0xf
    v_add_f32_dpp v12, v12, v12 quad_perm:[2,3,0,1] row_mask:0xf bank_mask:0xf
    v_add_f32_dpp v13, v13, v13 quad_perm:[2,3,0,1] row_mask:0xf bank_mask:0xf
    v_lshrrev_b32 v3, 5, v1
    v_lshlrev_b32 v3, 8, v3
    v_lshrrev_b32 v4, 2, v1
    v_and_b32 v4, 7, v4
    v_lshl_add_u32 v3, v4, 5, v3
    s_lshl_b32 s4, s82, 9
    v_add_u32 v3, s4, v3
    v_and_b32 v4, 3, v1
    v_cmp_eq_u32 vcc, 0, v4
    s_nop 0
    s_and_saveexec_b64 s[94:95], vcc
    ds_write_b128 v3, v[6:9] offset:28864
    ds_write_b128 v3, v[10:13] offset:28880
    s_mov_b64 exec, s[94:95]
    s_waitcnt lgkmcnt(0)
    v_mov_b32 v12, 17932
    v_mov_b32 v13, 1
    s_mov_b64 s[94:95], exec
    s_mov_b64 exec, 1
    ds_add_rtn_u32 v12, v12, v13
    s_mov_b64 exec, s[94:95]
    s_waitcnt lgkmcnt(0)
    v_readfirstlane_b32 s4, v12
    s_nop 3
    s_cmp_lg_u32 s4, 7
    s_cbranch_scc1 L_pc_skip_121
    v_mov_b32 v24, 17956
    s_mov_b32 s96, 0
L_clrspin_122:
    s_nop 2
    ds_read_b32 v25, v24
    s_waitcnt lgkmcnt(0)
    v_readfirstlane_b32 s4, v25
    s_nop 0
    s_cmp_eq_u32 s4, s42
    s_cbranch_scc1 L_clrok_123
    s_sleep 1
    s_add_u32 s96, s96, 1
    s_cmp_lt_u32 s96, 0x400000
    s_cbranch_scc1 L_clrspin_122
L_clrok_123:
    s_nop 2
    v_lshlrev_b32 v3, 3, v1
    ds_read_b64 v[10:11], v3 offset:28864
    ds_read_b64 v[12:13], v3 offset:29376
    ds_read_b64 v[14:15], v3 offset:29888
    ds_read_b64 v[16:17], v3 offset:30400
    ds_read_b64 v[18:19], v3 offset:30912
    ds_read_b64 v[20:21], v3 offset:31424
    ds_read_b64 v[22:23], v3 offset:31936
    ds_read_b64 v[24:25], v3 offset:32448
    v_lshrrev_b32 v8, 5, v1
    v_lshlrev_b32 v8, 12, v8
    v_and_b32 v9, 31, v1
    v_lshl_add_u32 v8, v9, 4, v8
    s_lshl_b32 s4, s72, 13
    s_lshl_b32 s5, s73, 9
    s_add_u32 s4, s4, s5
    s_add_u32 s4, s4, 0x300000
    s_waitcnt lgkmcnt(0)
    v_add_f32 v10, v10, v12
    v_add_f32 v11, v11, v13
    v_add_f32 v14, v14, v16
    v_add_f32 v15, v15, v17
    v_add_f32 v18, v18, v20
    v_add_f32 v19, v19, v21
    v_add_f32 v22, v22, v24
    v_add_f32 v23, v23, v25
    v_add_f32 v10, v10, v14
    v_add_f32 v11, v11, v15
    v_add_f32 v18, v18, v22
    v_add_f32 v19, v19, v23
    v_add_f32 v4, v10, v18
    v_add_f32 v6, v11, v19
    v_mov_b32 v5, s42
    v_mov_b32 v7, s42
    buffer_store_dwordx4 v[4:7], v8, s[60:63], s4 offen sc0 sc1
    s_nop 1
L_pc_skip_121:
    s_nop 2
    s_mov_b32 s100, 4
    s_branch L_sideloop_111
L_sidedone_110:
    s_nop 2
    v_and_b32 v28, 15, v1
    v_lshlrev_b32 v28, 5, v28
    v_lshrrev_b32 v29, 4, v1
    v_lshl_add_u32 v28, v29, 2, v28
    s_lshl_b32 s4, s3, 9
    v_add_u32 v28, s4, v28
    s_lshl_b32 s4, s3, 3
    v_mov_b32 v29, s4
    s_lshl_b32 s4, s87, 12
    v_add_u32 v30, s4, v28
    s_lshl_b32 s4, s87, 6
    v_add_u32 v31, s4, v29
    s_nop 2
    v_add_f32_dpp v57, v57, v57 row_half_mirror row_mask:0xf bank_mask:0xf
    v_mov_b32 v12, v56
    v_mov_b32 v13, v56
    v_add_f32_dpp v57, v57, v57 row_ror:8 row_mask:0xf bank_mask:0xf
    s_nop 0
    v_permlane16_swap_b32 v12, v13
    s_nop 0
    v_max_f32 v12, v12, v13
    v_mov_b32 v13, v12
    s_nop 1
    v_permlane32_swap_b32 v12, v13
    s_nop 0
    v_max_f32 v10, v12, v13
    v_sub_f32 v12, v56, v10
    v_mul_f32 v12, s43, v12
    v_exp_f32 v11, v12
    s_nop 0
    v_mul_f32 v40, v11, v40
    v_mul_f32 v41, v11, v41
    v_mul_f32 v42, v11, v42
    v_mul_f32 v43, v11, v43
    v_mul_f32 v44, v11, v44
    v_mul_f32 v45, v11, v45
    v_mul_f32 v46, v11, v46
    v_mul_f32 v47, v11, v47
    v_mul_f32 v57, v11, v57
    v_mov_b32 v13, v57
    v_permlane16_swap_b32 v40, v41
    v_permlane16_swap_b32 v42, v43
    v_permlane16_swap_b32 v44, v45
    v_permlane16_swap_b32 v46, v47
    v_permlane16_swap_b32 v57, v13
    s_nop 0
    v_add_f32 v40, v40, v41
    v_add_f32 v42, v42, v43
    v_add_f32 v44, v44, v45
    v_add_f32 v46, v46, v47
    v_add_f32 v57, v57, v13
    v_mov_b32 v13, v57
    s_nop 0
    v_permlane32_swap_b32 v40, v42
    v_permlane32_swap_b32 v44, v46
    v_permlane32_swap_b32 v57, v13
    s_nop 0
    v_add_f32 v40, v40, v42
    v_add_f32 v44, v44, v46
    v_add_f32 v57, v57, v13
    ds_write_b32 v30, v40 offset:20672
    ds_write_b32 v30, v44 offset:20688
    v_mov_b32 v12, v10
    v_mov_b32 v13, v57
    s_mov_b64 s[94:95], exec
    s_mov_b64 exec, 1
    ds_write_b64 v31, v[12:13] offset:18240
    s_mov_b64 exec, s[94:95]
    s_xor_b32 s5, s87, 1
    s_lshl_b32 s4, s5, 12
    v_add_u32 v30, s4, v28
    s_lshl_b32 s4, s5, 6
    v_add_u32 v31, s4, v29
    s_cmp_lg_u32 s99, 0
    s_cbranch_scc1 L_wother_124
    ds_write_b32 v30, v48 offset:20672
    ds_write_b32 v30, v48 offset:20688
    v_mov_b32 v12, v58
    v_mov_b32 v13, 0
    s_mov_b64 s[94:95], exec
    s_mov_b64 exec, 1
    ds_write_b64 v31, v[12:13] offset:18240
    s_mov_b64 exec, s[94:95]
    s_branch L_wdone_125
L_wother_124:
    s_nop 2
    s_nop 2
    v_add_f32_dpp v59, v59, v59 row_half_mirror row_mask:0xf bank_mask:0xf
    v_mov_b32 v12, v58
    v_mov_b32 v13, v58
    v_add_f32_dpp v59, v59, v59 row_ror:8 row_mask:0xf bank_mask:0xf
    s_nop 0
    v_permlane16_swap_b32 v12, v13
    s_nop 0
    v_max_f32 v12, v12, v13
    v_mov_b32 v13, v12
    s_nop 1
    v_permlane32_swap_b32 v12, v13
    s_nop 0
    v_max_f32 v10, v12, v13
    v_sub_f32 v12, v58, v10
    v_mul_f32 v12, s43, v12
    v_exp_f32 v11, v12
    s_nop 0
    v_mul_f32 v48, v11, v48
    v_mul_f32 v49, v11, v49
    v_mul_f32 v50, v11, v50
    v_mul_f32 v51, v11, v51
    v_mul_f32 v52, v11, v52
    v_mul_f32 v53, v11, v53
    v_mul_f32 v54, v11, v54
    v_mul_f32 v55, v11, v55
    v_mul_f32 v59, v11, v59
    v_mov_b32 v13, v59
    v_permlane16_swap_b32 v48, v49
    v_permlane16_swap_b32 v50, v51
    v_permlane16_swap_b32 v52, v53
    v_permlane16_swap_b32 v54, v55
    v_permlane16_swap_b32 v59, v13
    s_nop 0
    v_add_f32 v48, v48, v49
    v_add_f32 v50, v50, v51
    v_add_f32 v52, v52, v53
    v_add_f32 v54, v54, v55
    v_add_f32 v59, v59, v13
    v_mov_b32 v13, v59
    s_nop 0
    v_permlane32_swap_b32 v48, v50
    v_permlane32_swap_b32 v52, v54
    v_permlane32_swap_b32 v59, v13
    s_nop 0
    v_add_f32 v48, v48, v50
    v_add_f32 v52, v52, v54
    v_add_f32 v59, v59, v13
    ds_write_b32 v30, v48 offset:20672
    ds_write_b32 v30, v52 offset:20688
    v_mov_b32 v12, v10
    v_mov_b32 v13, v59
    s_mov_b64 s[94:95], exec
    s_mov_b64 exec, 1
    ds_write_b64 v31, v[12:13] offset:18240
    s_mov_b64 exec, s[94:95]
L_wdone_125:
    s_nop 2
    s_waitcnt lgkmcnt(0)
    v_mov_b32 v12, 17928
    v_mov_b32 v13, 1
    s_mov_b64 s[94:95], exec
    s_mov_b64 exec, 1
    ds_add_rtn_u32 v12, v12, v13
    s_mov_b64 exec, s[94:95]
    s_waitcnt lgkmcnt(0)
    v_readfirstlane_b32 s4, v12
    s_nop 3
    s_cmp_eq_u32 s4, 0
    s_cbranch_scc1 L_bfirst_127
    s_cmp_lg_u32 s4, 7
    s_cbranch_scc1 L_bmerged_126
    s_lshl_b32 s74, s72, 4
    s_add_u32 s74, s74, s73
    s_lshl_b32 s75, s74, 4
    s_add_u32 s75, s75, 0x28000
    s_lshl_b32 s74, s74, 10
    s_add_u32 s74, s74, 0x200000
    v_lshlrev_b32 v3, 3, v1
    v_mov_b32 v4, 0
    ds_read_b64 v[16:17], v3 offset:20672
    ds_read_b64 v[18:19], v3 offset:21184
    ds_read_b64 v[20:21], v3 offset:21696
    ds_read_b64 v[22:23], v3 offset:22208
    ds_read_b64 v[24:25], v3 offset:22720
    ds_read_b64 v[26:27], v3 offset:23232
    ds_read_b64 v[28:29], v3 offset:23744
    ds_read_b64 v[30:31], v3 offset:24256
    ds_read_b128 v[128:131], v4 offset:18240
    ds_read_b128 v[132:135], v4 offset:18256
    ds_read_b128 v[136:139], v4 offset:18272
    ds_read_b128 v[140:143], v4 offset:18288
    s_waitcnt lgkmcnt(0)
    v_max3_f32 v5, v128, v130, v132
    v_max3_f32 v5, v5, v134, v136
    v_max3_f32 v5, v5, v138, v140
    v_max_f32 v5, v5, v142
    v_sub_f32 v128, v128, v5
    v_mul_f32 v128, s43, v128
    v_exp_f32 v128, v128
    v_sub_f32 v130, v130, v5
    v_mul_f32 v130, s43, v130
    v_exp_f32 v130, v130
    v_sub_f32 v132, v132, v5
    v_mul_f32 v132, s43, v132
    v_exp_f32 v132, v132
    v_sub_f32 v134, v134, v5
    v_mul_f32 v134, s43, v134
    v_exp_f32 v134, v134
    v_sub_f32 v136, v136, v5
    v_mul_f32 v136, s43, v136
    v_exp_f32 v136, v136
    v_sub_f32 v138, v138, v5
    v_mul_f32 v138, s43, v138
    v_exp_f32 v138, v138
    v_sub_f32 v140, v140, v5
    v_mul_f32 v140, s43, v140
    v_exp_f32 v140, v140
    v_sub_f32 v142, v142, v5
    v_mul_f32 v142, s43, v142
    v_exp_f32 v142, v142
    s_nop 0
    v_mul_f32 v6, v128, v16
    v_mul_f32 v8, v128, v17
    v_mul_f32 v12, v128, v129
    v_fmac_f32 v6, v130, v18
    v_fmac_f32 v8, v130, v19
    v_fmac_f32 v12, v130, v131
    v_fmac_f32 v6, v132, v20
    v_fmac_f32 v8, v132, v21
    v_fmac_f32 v12, v132, v133
    v_fmac_f32 v6, v134, v22
    v_fmac_f32 v8, v134, v23
    v_fmac_f32 v12, v134, v135
    v_fmac_f32 v6, v136, v24
    v_fmac_f32 v8, v136, v25
    v_fmac_f32 v12, v136, v137
    v_fmac_f32 v6, v138, v26
    v_fmac_f32 v8, v138, v27
    v_fmac_f32 v12, v138, v139
    v_fmac_f32 v6, v140, v28
    v_fmac_f32 v8, v140, v29
    v_fmac_f32 v12, v140, v141
    v_fmac_f32 v6, v142, v30
    v_fmac_f32 v8, v142, v31
    v_fmac_f32 v12, v142, v143
    v_mov_b32 v7, s42
    v_mov_b32 v9, s42
    buffer_store_dwordx4 v[6:9], v2, s[60:63], s74 offen sc0 sc1
    v_mov_b32 v10, v5
    v_mov_b32 v11, s42
    v_mov_b32 v13, s42
    v_mov_b32 v4, 0
    s_mov_b64 s[94:95], exec
    s_mov_b64 exec, 1
    buffer_store_dwordx4 v[10:13], v4, s[60:63], s75 offen sc0 sc1
    s_mov_b64 exec, s[94:95]
    s_nop 1
    s_add_u32 s74, s74, 8192
    s_add_u32 s75, s75, 128
    v_lshlrev_b32 v3, 3, v1
    v_mov_b32 v4, 0
    ds_read_b64 v[16:17], v3 offset:24768
    ds_read_b64 v[18:19], v3 offset:25280
    ds_read_b64 v[20:21], v3 offset:25792
    ds_read_b64 v[22:23], v3 offset:26304
    ds_read_b64 v[24:25], v3 offset:26816
    ds_read_b64 v[26:27], v3 offset:27328
    ds_read_b64 v[28:29], v3 offset:27840
    ds_read_b64 v[30:31], v3 offset:28352
    ds_read_b128 v[128:131], v4 offset:18304
    ds_read_b128 v[132:135], v4 offset:18320
    ds_read_b128 v[136:139], v4 offset:18336
    ds_read_b128 v[140:143], v4 offset:18352
    s_waitcnt lgkmcnt(0)
    v_max3_f32 v5, v128, v130, v132
    v_max3_f32 v5, v5, v134, v136
    v_max3_f32 v5, v5, v138, v140
    v_max_f32 v5, v5, v142
    v_sub_f32 v128, v128, v5
    v_mul_f32 v128, s43, v128
    v_exp_f32 v128, v128
    v_sub_f32 v130, v130, v5
    v_mul_f32 v130, s43, v130
    v_exp_f32 v130, v130
    v_sub_f32 v132, v132, v5
    v_mul_f32 v132, s43, v132
    v_exp_f32 v132, v132
    v_sub_f32 v134, v134, v5
    v_mul_f32 v134, s43, v134
    v_exp_f32 v134, v134
    v_sub_f32 v136, v136, v5
    v_mul_f32 v136, s43, v136
    v_exp_f32 v136, v136
    v_sub_f32 v138, v138, v5
    v_mul_f32 v138, s43, v138
    v_exp_f32 v138, v138
    v_sub_f32 v140, v140, v5
    v_mul_f32 v140, s43, v140
    v_exp_f32 v140, v140
    v_sub_f32 v142, v142, v5
    v_mul_f32 v142, s43, v142
    v_exp_f32 v142, v142
    s_nop 0
    v_mul_f32 v6, v128, v16
    v_mul_f32 v8, v128, v17
    v_mul_f32 v12, v128, v129
    v_fmac_f32 v6, v130, v18
    v_fmac_f32 v8, v130, v19
    v_fmac_f32 v12, v130, v131
    v_fmac_f32 v6, v132, v20
    v_fmac_f32 v8, v132, v21
    v_fmac_f32 v12, v132, v133
    v_fmac_f32 v6, v134, v22
    v_fmac_f32 v8, v134, v23
    v_fmac_f32 v12, v134, v135
    v_fmac_f32 v6, v136, v24
    v_fmac_f32 v8, v136, v25
    v_fmac_f32 v12, v136, v137
    v_fmac_f32 v6, v138, v26
    v_fmac_f32 v8, v138, v27
    v_fmac_f32 v12, v138, v139
    v_fmac_f32 v6, v140, v28
    v_fmac_f32 v8, v140, v29
    v_fmac_f32 v12, v140, v141
    v_fmac_f32 v6, v142, v30
    v_fmac_f32 v8, v142, v31
    v_fmac_f32 v12, v142, v143
    v_mov_b32 v7, s42
    v_mov_b32 v9, s42
    buffer_store_dwordx4 v[6:9], v2, s[60:63], s74 offen sc0 sc1
    v_mov_b32 v10, v5
    v_mov_b32 v11, s42
    v_mov_b32 v13, s42
    v_mov_b32 v4, 0
    s_mov_b64 s[94:95], exec
    s_mov_b64 exec, 1
    buffer_store_dwordx4 v[10:13], v4, s[60:63], s75 offen sc0 sc1
    s_mov_b64 exec, s[94:95]
    s_nop 1
    s_branch L_bmerged_126
L_bfirst_127:
    s_nop 2
    s_lshl_b32 s4, s72, 8
    s_add_u32 s4, s4, 0x28000
    s_mov_b32 s96, 0
    s_mov_b64 exec, 0xffff
L_lpoll_129:
    s_nop 2
    buffer_load_dwordx4 v[4:7], v2, s[60:63], s4 offen sc0 sc1
    s_waitcnt vmcnt(0)
    v_xor_b32 v24, s42, v5
    v_xor_b32 v25, s42, v7
    v_or_b32 v24, v24, v25
    v_cmp_ne_u32 vcc, 0, v24
    s_nop 0
    s_cmp_eq_u64 vcc, 0
    s_bcnt1_i32_b64 s5, vcc
    s_cmp_le_u32 s5, 2
    s_cbranch_scc1 L_lpoll_ok_130
    s_sleep 2
    s_add_u32 s96, s96, 1
    s_cmp_lt_u32 s96, 0x20000
    s_cbranch_scc1 L_lpoll_129
L_lpoll_ok_130:
    s_nop 2
    s_mov_b64 exec, -1
    v_mov_b32 v3, 17940
    v_mov_b32 v4, 1
    ds_write_b32 v3, v4
L_bmerged_126:
    s_nop 2
    v_lshlrev_b32 v60, 16, v208
    v_and_b32 v61, 0xffff0000, v208
    v_lshlrev_b32 v62, 16, v209
    v_and_b32 v63, 0xffff0000, v209
    v_lshlrev_b32 v64, 16, v210
    v_and_b32 v65, 0xffff0000, v210
    v_lshlrev_b32 v66, 16, v211
    v_and_b32 v67, 0xffff0000, v211
    v_lshlrev_b32 v68, 16, v212
    v_and_b32 v69, 0xffff0000, v212
    v_lshlrev_b32 v70, 16, v213
    v_and_b32 v71, 0xffff0000, v213
    v_lshlrev_b32 v72, 16, v214
    v_and_b32 v73, 0xffff0000, v214
    v_lshlrev_b32 v74, 16, v215
    v_and_b32 v75, 0xffff0000, v215
    v_lshlrev_b32 v76, 16, v216
    v_and_b32 v77, 0xffff0000, v216
    v_lshlrev_b32 v78, 16, v217
    v_and_b32 v79, 0xffff0000, v217
    v_lshlrev_b32 v80, 16, v218
    v_and_b32 v81, 0xffff0000, v218
    v_lshlrev_b32 v82, 16, v219
    v_and_b32 v83, 0xffff0000, v219
    v_lshlrev_b32 v84, 16, v220
    v_and_b32 v85, 0xffff0000, v220
    v_lshlrev_b32 v86, 16, v221
    v_and_b32 v87, 0xffff0000, v221
    v_lshlrev_b32 v88, 16, v222
    v_and_b32 v89, 0xffff0000, v222
    v_lshlrev_b32 v90, 16, v223
    v_and_b32 v91, 0xffff0000, v223
    v_lshrrev_b32 v26, 5, v1
    v_lshlrev_b32 v26, 8, v26
    v_lshrrev_b32 v4, 2, v1
    v_and_b32 v4, 7, v4
    v_lshl_add_u32 v26, v4, 5, v26
    v_mov_b32 v3, 17940
    s_mov_b32 s96, 0
L_fspin_131:
    s_nop 2
    ds_read_b32 v4, v3
    s_waitcnt lgkmcnt(0)
    v_readfirstlane_b32 s4, v4
    s_nop 0
    s_cmp_lg_u32 s4, 0
    s_cbranch_scc1 L_fspin_ok_132
    s_sleep 1
    s_add_u32 s96, s96, 1
    s_cmp_lt_u32 s96, 0x400000
    s_cbranch_scc1 L_fspin_131
L_fspin_ok_132:
    s_nop 2
    v_lshrrev_b32 v3, 5, v1
    v_lshrrev_b32 v4, 2, v1
    v_and_b32 v4, 7, v4
    v_lshlrev_b32 v3, 3, v3
    v_add_u32 v3, v3, v4
    s_lshl_b32 s74, s72, 4
    v_add_u32 v3, s74, v3
    v_lshlrev_b32 v5, 4, v3
    v_lshlrev_b32 v6, 10, v3
    v_and_b32 v4, 3, v1
    v_lshl_add_u32 v6, v4, 5, v6
    s_lshl_b32 s74, s3, 7
    s_add_u32 s74, s74, 0x200000
    s_mov_b32 s75, 0x28000
    s_add_u32 s76, s74, 8192
    s_add_u32 s77, s75, 128
    s_mov_b32 s96, 0
L_pc_poll_134:
    s_nop 2
    buffer_load_dwordx4 v[224:227], v6, s[60:63], s74 offen sc0 sc1
    buffer_load_dwordx4 v[228:231], v6, s[60:63], s74 offen offset:16 sc0 sc1
    buffer_load_dwordx4 v[232:235], v5, s[60:63], s75 offen sc0 sc1
    s_waitcnt vmcnt(0)
    s_mov_b64 exec, -1
    v_xor_b32 v24, s42, v225
    v_xor_b32 v25, s42, v227
    v_or_b32 v24, v24, v25
    v_xor_b32 v25, s42, v229
    v_or_b32 v24, v24, v25
    v_xor_b32 v25, s42, v231
    v_or_b32 v24, v24, v25
    v_xor_b32 v25, s42, v233
    v_or_b32 v24, v24, v25
    v_xor_b32 v25, s42, v235
    v_or_b32 v24, v24, v25
    v_cmp_ne_u32 vcc, 0, v24
    s_nop 0
    s_cmp_eq_u64 vcc, 0
    s_cbranch_scc1 L_pc_ok_133
    s_mov_b64 exec, vcc
    s_add_u32 s96, s96, 1
    s_cmp_lt_u32 s96, 0x20000
    s_cbranch_scc1 L_pc_poll_134
    s_mov_b64 exec, -1
L_pc_ok_133:
    s_nop 2
    v_mov_b32 v3, v232
    s_nop 1
    v_max_f32_dpp v3, v3, v3 row_ror:4 row_mask:0xf bank_mask:0xf
    s_nop 1
    v_max_f32_dpp v3, v3, v3 row_ror:8 row_mask:0xf bank_mask:0xf
    v_mov_b32 v4, v3
    s_nop 1
    v_permlane16_swap_b32 v3, v4
    s_nop 0
    v_max_f32 v3, v3, v4
    v_sub_f32 v4, v232, v3
    v_mul_f32 v4, s43, v4
    v_exp_f32 v4, v4
    s_nop 0
    v_mul_f32 v6, v4, v224
    v_mul_f32 v7, v4, v226
    v_mul_f32 v8, v4, v228
    v_mul_f32 v9, v4, v230
    v_mul_f32 v10, v4, v234
    s_nop 0
    v_add_f32_dpp v6, v6, v6 row_ror:4 row_mask:0xf bank_mask:0xf
    v_add_f32_dpp v7, v7, v7 row_ror:4 row_mask:0xf bank_mask:0xf
    v_add_f32_dpp v8, v8, v8 row_ror:4 row_mask:0xf bank_mask:0xf
    v_add_f32_dpp v9, v9, v9 row_ror:4 row_mask:0xf bank_mask:0xf
    v_add_f32_dpp v10, v10, v10 row_ror:4 row_mask:0xf bank_mask:0xf
    v_add_f32_dpp v6, v6, v6 row_ror:8 row_mask:0xf bank_mask:0xf
    v_add_f32_dpp v7, v7, v7 row_ror:8 row_mask:0xf bank_mask:0xf
    v_add_f32_dpp v8, v8, v8 row_ror:8 row_mask:0xf bank_mask:0xf
    v_add_f32_dpp v9, v9, v9 row_ror:8 row_mask:0xf bank_mask:0xf
    v_add_f32_dpp v10, v10, v10 row_ror:8 row_mask:0xf bank_mask:0xf
    v_mov_b32 v11, v6
    v_mov_b32 v12, v7
    v_mov_b32 v13, v8
    v_mov_b32 v14, v9
    v_mov_b32 v15, v10
    s_nop 0
    v_permlane16_swap_b32 v6, v11
    v_permlane16_swap_b32 v7, v12
    v_permlane16_swap_b32 v8, v13
    v_permlane16_swap_b32 v9, v14
    v_permlane16_swap_b32 v10, v15
    s_nop 0
    v_add_f32 v6, v6, v11
    v_add_f32 v7, v7, v12
    v_add_f32 v8, v8, v13
    v_add_f32 v9, v9, v14
    v_add_f32 v10, v10, v15
    v_rcp_f32 v10, v10
    s_nop 0
    v_mul_f32 v6, v10, v6
    v_mul_f32 v7, v10, v7
    v_mul_f32 v8, v10, v8
    v_mul_f32 v9, v10, v9
    v_cvt_pk_bf16_f32 v16, v6, 0
    v_cvt_pk_bf16_f32 v17, v7, 0
    v_cvt_pk_bf16_f32 v18, v8, 0
    v_cvt_pk_bf16_f32 v19, v9, 0
    v_lshlrev_b32 v16, 16, v16
    v_lshlrev_b32 v17, 16, v17
    v_lshlrev_b32 v18, 16, v18
    v_lshlrev_b32 v19, 16, v19
    v_mul_f32 v6, v16, v60
    v_mul_f32 v7, v16, v61
    v_mul_f32 v8, v16, v62
    v_mul_f32 v9, v16, v63
    v_mul_f32 v10, v16, v64
    v_mul_f32 v11, v16, v65
    v_mul_f32 v12, v16, v66
    v_mul_f32 v13, v16, v67
    v_fmac_f32 v6, v17, v68
    v_fmac_f32 v7, v17, v69
    v_fmac_f32 v8, v17, v70
    v_fmac_f32 v9, v17, v71
    v_fmac_f32 v10, v17, v72
    v_fmac_f32 v11, v17, v73
    v_fmac_f32 v12, v17, v74
    v_fmac_f32 v13, v17, v75
    v_fmac_f32 v6, v18, v76
    v_fmac_f32 v7, v18, v77
    v_fmac_f32 v8, v18, v78
    v_fmac_f32 v9, v18, v79
    v_fmac_f32 v10, v18, v80
    v_fmac_f32 v11, v18, v81
    v_fmac_f32 v12, v18, v82
    v_fmac_f32 v13, v18, v83
    v_fmac_f32 v6, v19, v84
    v_fmac_f32 v7, v19, v85
    v_fmac_f32 v8, v19, v86
    v_fmac_f32 v9, v19, v87
    v_fmac_f32 v10, v19, v88
    v_fmac_f32 v11, v19, v89
    v_fmac_f32 v12, v19, v90
    v_fmac_f32 v13, v19, v91
    v_add_f32_dpp v6, v6, v6 quad_perm:[1,0,3,2] row_mask:0xf bank_mask:0xf
    v_add_f32_dpp v7, v7, v7 quad_perm:[1,0,3,2] row_mask:0xf bank_mask:0xf
    v_add_f32_dpp v8, v8, v8 quad_perm:[1,0,3,2] row_mask:0xf bank_mask:0xf
    v_add_f32_dpp v9, v9, v9 quad_perm:[1,0,3,2] row_mask:0xf bank_mask:0xf
    v_add_f32_dpp v10, v10, v10 quad_perm:[1,0,3,2] row_mask:0xf bank_mask:0xf
    v_add_f32_dpp v11, v11, v11 quad_perm:[1,0,3,2] row_mask:0xf bank_mask:0xf
    v_add_f32_dpp v12, v12, v12 quad_perm:[1,0,3,2] row_mask:0xf bank_mask:0xf
    v_add_f32_dpp v13, v13, v13 quad_perm:[1,0,3,2] row_mask:0xf bank_mask:0xf
    v_add_f32_dpp v6, v6, v6 quad_perm:[2,3,0,1] row_mask:0xf bank_mask:0xf
    v_add_f32_dpp v7, v7, v7 quad_perm:[2,3,0,1] row_mask:0xf bank_mask:0xf
    v_add_f32_dpp v8, v8, v8 quad_perm:[2,3,0,1] row_mask:0xf bank_mask:0xf
    v_add_f32_dpp v9, v9, v9 quad_perm:[2,3,0,1] row_mask:0xf bank_mask:0xf
    v_add_f32_dpp v10, v10, v10 quad_perm:[2,3,0,1] row_mask:0xf bank_mask:0xf
    v_add_f32_dpp v11, v11, v11 quad_perm:[2,3,0,1] row_mask:0xf bank_mask:0xf
    v_add_f32_dpp v12, v12, v12 quad_perm:[2,3,0,1] row_mask:0xf bank_mask:0xf
    v_add_f32_dpp v13, v13, v13 quad_perm:[2,3,0,1] row_mask:0xf bank_mask:0xf
    v_lshrrev_b32 v3, 5, v1
    v_lshlrev_b32 v3, 8, v3
    v_lshrrev_b32 v4, 2, v1
    v_and_b32 v4, 7, v4
    v_lshl_add_u32 v3, v4, 5, v3
    s_lshl_b32 s4, s3, 9
    v_add_u32 v3, s4, v3
    v_and_b32 v4, 3, v1
    v_cmp_eq_u32 vcc, 0, v4
    s_nop 0
    s_and_saveexec_b64 s[94:95], vcc
    ds_write_b128 v3, v[6:9] offset:20672
    ds_write_b128 v3, v[10:13] offset:20688
    s_mov_b64 exec, s[94:95]
    s_waitcnt lgkmcnt(0)
    v_mov_b32 v12, 17936
    v_mov_b32 v13, 1
    s_mov_b64 s[94:95], exec
    s_mov_b64 exec, 1
    ds_add_rtn_u32 v12, v12, v13
    s_mov_b64 exec, s[94:95]
    s_waitcnt lgkmcnt(0)
    v_readfirstlane_b32 s4, v12
    s_nop 3
    s_cmp_lg_u32 s4, 7
    s_cbranch_scc1 L_pc_skip_135
    v_lshlrev_b32 v3, 3, v1
    ds_read_b64 v[10:11], v3 offset:20672
    ds_read_b64 v[12:13], v3 offset:21184
    ds_read_b64 v[14:15], v3 offset:21696
    ds_read_b64 v[16:17], v3 offset:22208
    ds_read_b64 v[18:19], v3 offset:22720
    ds_read_b64 v[20:21], v3 offset:23232
    ds_read_b64 v[22:23], v3 offset:23744
    ds_read_b64 v[24:25], v3 offset:24256
    v_lshrrev_b32 v8, 5, v1
    v_lshlrev_b32 v8, 12, v8
    v_and_b32 v9, 31, v1
    v_lshl_add_u32 v8, v9, 4, v8
    s_lshl_b32 s4, s72, 13
    s_lshl_b32 s5, s73, 9
    s_add_u32 s4, s4, s5
    s_add_u32 s4, s4, 0x340000
    s_waitcnt lgkmcnt(0)
    v_add_f32 v10, v10, v12
    v_add_f32 v11, v11, v13
    v_add_f32 v14, v14, v16
    v_add_f32 v15, v15, v17
    v_add_f32 v18, v18, v20
    v_add_f32 v19, v19, v21
    v_add_f32 v22, v22, v24
    v_add_f32 v23, v23, v25
    v_add_f32 v10, v10, v14
    v_add_f32 v11, v11, v15
    v_add_f32 v18, v18, v22
    v_add_f32 v19, v19, v23
    v_add_f32 v4, v10, v18
    v_add_f32 v6, v11, v19
    v_mov_b32 v5, s42
    v_mov_b32 v7, s42
    buffer_store_dwordx4 v[4:7], v8, s[60:63], s4 offen sc0 sc1
    s_nop 1
L_pc_skip_135:
    s_nop 2
    s_cmp_eq_u32 s100, 2
    s_cbranch_scc1 L_noD2_136
    s_cmp_lg_u32 s3, 1
    s_cbranch_scc1 L_noD2_136
    s_and_b32 s4, s2, 3
    s_cmp_lg_u32 s4, 1
    s_cbranch_scc1 L_noD2_136
    s_lshr_b32 s74, s2, 2
    s_lshr_b32 s75, s74, 5
    s_and_b32 s76, s74, 31
    v_lshrrev_b32 v3, 4, v1
    v_lshlrev_b32 v3, 16, v3
    v_and_b32 v4, 15, v1
    v_lshl_add_u32 v3, v4, 3, v3
    s_lshl_b32 s4, s75, 12
    s_lshl_b32 s5, s76, 7
    s_add_u32 s4, s4, s5
    s_add_u32 s4, s4, 0x300000
    s_mov_b32 s96, 0
L_pd_poll_137:
    s_nop 2
    s_mov_b32 s5, s4
    buffer_load_dwordx2 v[224:225], v3, s[60:63], s5 offen sc0 sc1
    s_add_u32 s5, s5, 8192
    buffer_load_dwordx2 v[226:227], v3, s[60:63], s5 offen sc0 sc1
    s_add_u32 s5, s5, 8192
    buffer_load_dwordx2 v[228:229], v3, s[60:63], s5 offen sc0 sc1
    s_add_u32 s5, s5, 8192
    buffer_load_dwordx2 v[230:231], v3, s[60:63], s5 offen sc0 sc1
    s_add_u32 s5, s5, 8192
    buffer_load_dwordx2 v[232:233], v3, s[60:63], s5 offen sc0 sc1
    s_add_u32 s5, s5, 8192
    buffer_load_dwordx2 v[234:235], v3, s[60:63], s5 offen sc0 sc1
    s_add_u32 s5, s5, 8192
    buffer_load_dwordx2 v[236:237], v3, s[60:63], s5 offen sc0 sc1
    s_add_u32 s5, s5, 8192
    buffer_load_dwordx2 v[238:239], v3, s[60:63], s5 offen sc0 sc1
    s_waitcnt vmcnt(0)
    v_xor_b32 v24, s42, v225
    v_xor_b32 v25, s42, v227
    v_or_b32 v24, v24, v25
    v_xor_b32 v25, s42, v229
    v_or_b32 v24, v24, v25
    v_xor_b32 v25, s42, v231
    v_or_b32 v24, v24, v25
    v_xor_b32 v25, s42, v233
    v_or_b32 v24, v24, v25
    v_xor_b32 v25, s42, v235
    v_or_b32 v24, v24, v25
    v_xor_b32 v25, s42, v237
    v_or_b32 v24, v24, v25
    v_xor_b32 v25, s42, v239
    v_or_b32 v24, v24, v25
    v_cmp_ne_u32 vcc, 0, v24
    s_nop 0
    s_cmp_eq_u64 vcc, 0
    s_cbranch_scc1 L_pd_ok_138
    s_sleep 64
    s_add_u32 s96, s96, 1
    s_cmp_lt_u32 s96, 0x20000
    s_cbranch_scc1 L_pd_poll_137
L_pd_ok_138:
    s_nop 2
    v_add_f32 v5, v224, v226
    v_add_f32 v5, v5, v228
    v_add_f32 v5, v5, v230
    v_add_f32 v5, v5, v232
    v_add_f32 v5, v5, v234
    v_add_f32 v5, v5, v236
    v_add_f32 v5, v5, v238
    v_mov_b32 v6, v5
    s_nop 1
    v_permlane16_swap_b32 v5, v6
    s_nop 0
    v_add_f32 v5, v5, v6
    v_mov_b32 v6, v5
    s_nop 1
    v_permlane32_swap_b32 v5, v6
    s_nop 0
    v_add_f32 v5, v5, v6
    s_nop 1
    v_mov_b32_dpp v6, v5 quad_perm:[1,0,3,2] row_mask:0xf bank_mask:0xf
    v_cvt_pk_bf16_f32 v7, v5, v6
    s_mov_b32 s64, s36
    s_and_b32 s65, s37, 0xffff
    s_mov_b32 s66, 0x1000
    s_mov_b32 s67, 0x00020000
    s_lshl_b32 s4, s75, 11
    s_lshl_b32 s5, s76, 5
    s_add_u32 s4, s4, s5
    s_add_u32 s4, s4, 0
    v_lshlrev_b32 v3, 1, v1
    s_mov_b64 s[94:95], exec
    s_mov_b64 exec, 0x5555
    buffer_store_dword v7, v3, s[64:67], s4 offen
    s_mov_b64 exec, s[94:95]
L_noD2_136:
    s_nop 2
    s_cmp_lg_u32 s3, 0
    s_cbranch_scc1 L_fin
    s_and_b32 s4, s2, 3
    s_cmp_lg_u32 s4, 0
    s_cbranch_scc1 L_fin
    s_lshr_b32 s74, s2, 2
    s_lshr_b32 s75, s74, 5
    s_and_b32 s76, s74, 31
    v_lshrrev_b32 v3, 4, v1
    v_lshlrev_b32 v3, 16, v3
    v_and_b32 v4, 15, v1
    v_lshl_add_u32 v3, v4, 3, v3
    s_lshl_b32 s4, s75, 12
    s_lshl_b32 s5, s76, 7
    s_add_u32 s4, s4, s5
    s_add_u32 s4, s4, 0x340000
    s_mov_b32 s96, 0
L_pd_poll_139:
    s_nop 2
    s_mov_b32 s5, s4
    buffer_load_dwordx2 v[224:225], v3, s[60:63], s5 offen sc0 sc1
    s_add_u32 s5, s5, 8192
    buffer_load_dwordx2 v[226:227], v3, s[60:63], s5 offen sc0 sc1
    s_add_u32 s5, s5, 8192
    buffer_load_dwordx2 v[228:229], v3, s[60:63], s5 offen sc0 sc1
    s_add_u32 s5, s5, 8192
    buffer_load_dwordx2 v[230:231], v3, s[60:63], s5 offen sc0 sc1
    s_add_u32 s5, s5, 8192
    buffer_load_dwordx2 v[232:233], v3, s[60:63], s5 offen sc0 sc1
    s_add_u32 s5, s5, 8192
    buffer_load_dwordx2 v[234:235], v3, s[60:63], s5 offen sc0 sc1
    s_add_u32 s5, s5, 8192
    buffer_load_dwordx2 v[236:237], v3, s[60:63], s5 offen sc0 sc1
    s_add_u32 s5, s5, 8192
    buffer_load_dwordx2 v[238:239], v3, s[60:63], s5 offen sc0 sc1
    s_waitcnt vmcnt(0)
    v_xor_b32 v24, s42, v225
    v_xor_b32 v25, s42, v227
    v_or_b32 v24, v24, v25
    v_xor_b32 v25, s42, v229
    v_or_b32 v24, v24, v25
    v_xor_b32 v25, s42, v231
    v_or_b32 v24, v24, v25
    v_xor_b32 v25, s42, v233
    v_or_b32 v24, v24, v25
    v_xor_b32 v25, s42, v235
    v_or_b32 v24, v24, v25
    v_xor_b32 v25, s42, v237
    v_or_b32 v24, v24, v25
    v_xor_b32 v25, s42, v239
    v_or_b32 v24, v24, v25
    v_cmp_ne_u32 vcc, 0, v24
    s_nop 0
    s_cmp_eq_u64 vcc, 0
    s_cbranch_scc1 L_pd_ok_140
    s_sleep 2
    s_add_u32 s96, s96, 1
    s_cmp_lt_u32 s96, 0x20000
    s_cbranch_scc1 L_pd_poll_139
L_pd_ok_140:
    s_nop 2
    v_add_f32 v5, v224, v226
    v_add_f32 v5, v5, v228
    v_add_f32 v5, v5, v230
    v_add_f32 v5, v5, v232
    v_add_f32 v5, v5, v234
    v_add_f32 v5, v5, v236
    v_add_f32 v5, v5, v238
    v_mov_b32 v6, v5
    s_nop 1
    v_permlane16_swap_b32 v5, v6
    s_nop 0
    v_add_f32 v5, v5, v6
    v_mov_b32 v6, v5
    s_nop 1
    v_permlane32_swap_b32 v5, v6
    s_nop 0
    v_add_f32 v5, v5, v6
    s_nop 1
    v_mov_b32_dpp v6, v5 quad_perm:[1,0,3,2] row_mask:0xf bank_mask:0xf
    v_cvt_pk_bf16_f32 v7, v5, v6
    s_mov_b32 s64, s36
    s_and_b32 s65, s37, 0xffff
    s_mov_b32 s66, 0x1000
    s_mov_b32 s67, 0x00020000
    s_lshl_b32 s4, s75, 11
    s_lshl_b32 s5, s76, 5
    s_add_u32 s4, s4, s5
    s_add_u32 s4, s4, 1024
    v_lshlrev_b32 v3, 1, v1
    s_mov_b64 s[94:95], exec
    s_mov_b64 exec, 0x5555
    buffer_store_dword v7, v3, s[64:67], s4 offen
    s_mov_b64 exec, s[94:95]
    s_cmp_lg_u32 s2, 0
    s_cbranch_scc1 L_noE_141
    v_mov_b32 v3, 0
    v_mov_b32 v4, s42
    s_mov_b64 s[94:95], exec
    s_mov_b64 exec, 1
    buffer_store_dword v4, v3, s[60:63], 0 offen sc0 sc1
    s_mov_b64 exec, s[94:95]
L_noE_141:
    s_nop 2
L_fin:
    s_nop 2
L_end:
    s_nop 2
    s_endpgm
L_code_end:
.section .rodata,"a"
.p2align 6
.amdhsa_kernel concat_heads__sliding_block_cached__mha_block_cached__decode_kernel
  .amdhsa_next_free_vgpr 256
  .amdhsa_next_free_sgpr 102
  .amdhsa_accum_offset 256
  .amdhsa_group_segment_fixed_size 0
  .amdhsa_kernarg_size 104
  .amdhsa_user_sgpr_count 2
  .amdhsa_user_sgpr_kernarg_segment_ptr 1
  .amdhsa_system_sgpr_workgroup_id_x 1
.end_amdhsa_kernel
```
